```python
import torch

def _softmax(x, axis=-1):
    return torch.softmax(x, dim=axis)
def _gelu(x):
    return torch.nn.functional.gelu(x, approximate="tanh")
def _silu(x):
    return torch.nn.functional.silu(x)
def _sigmoid(x):
    return torch.sigmoid(x)
def _layernorm(x, axis=-1, eps=1e-5):
    m = x.mean(dim=axis, keepdim=True)
    v = x.var(dim=axis, keepdim=True, unbiased=False)
    return (x - m) / torch.sqrt(v + eps)
def _scatter_add(tgt, idx, src, axis=0):
    return tgt.clone().index_add_(axis, idx, src)
def _segment_sum(src, seg, n):
    out = torch.zeros((n,) + src.shape[1:], dtype=src.dtype)
    return out.index_add_(0, seg, src)
def _pad(x, pw):
    flat = tuple(v for pair in reversed(pw) for v in pair)
    return torch.nn.functional.pad(x, flat)

kernel_name = 'standalone__dense_activation_squared_relu__prompt'

def setup_inputs():

    _w = (lambda a: (lambda t: t.to(torch.bfloat16) if t.is_floating_point() else t)(torch.as_tensor(a)))
    B, S, D, F = 1, 2048, 640, 1728
    return {
        "x": _w((lambda *s: torch.randn(*s, dtype=torch.bfloat16) * 0.05)(B, S, D)),
        "w1": _w((lambda *s: torch.randn(*s, dtype=torch.bfloat16) * 0.05)(D, F)),
        "b1": _w((lambda *s: torch.randn(*s, dtype=torch.bfloat16) * 0.05)(F)),
        "w2": _w((lambda *s: torch.randn(*s, dtype=torch.bfloat16) * 0.05)(F, D)),
        "b2": _w((lambda *s: torch.randn(*s, dtype=torch.bfloat16) * 0.05)(D)),
    }

def reference(x, w1, b1, w2, b2):
    h = torch.einsum("bsd,df->bsf", x, w1) + b1
    zero = torch.zeros_like(h)
    r = torch.where(h > zero, h, zero)
    h = r * r
    out = torch.einsum("bsf,fd->bsd", h, w2) + b2
    return out
```

```asm
; @launch kernel=standalone__dense_activation_squared_relu__prompt_kernel grid=(256,1,1) block=(512,1,1) lds=131072
; @launch kernel=mlp_gemm2_kernel grid=(256,1,1) block=(512,1,1) lds=143360
.amdgcn_target "amdgcn-amd-amdhsa--gfx950"
.text
.globl standalone__dense_activation_squared_relu__prompt_kernel
.p2align 8
.type standalone__dense_activation_squared_relu__prompt_kernel,@function
standalone__dense_activation_squared_relu__prompt_kernel:
    s_cmp_ge_u32 s2, 256
    s_cbranch_scc1 .Lk1_end
    s_load_dwordx2 s[4:5], s[0:1], 0
    s_load_dwordx2 s[8:9], s[0:1], 8
    s_load_dwordx2 s[12:13], s[0:1], 16
    s_load_dwordx2 s[16:17], s[0:1], 56
    s_load_dwordx2 s[20:21], s[0:1], 24
    s_and_b32 s24, s2, 7
    s_lshr_b32 s25, s2, 3
    v_lshrrev_b32 v4, 6, v0
    v_and_b32 v1, 63, v0
    s_nop 0
    v_readfirstlane_b32 s28, v4
    v_and_b32 v2, 15, v1
    v_lshrrev_b32 v3, 4, v1
    s_mul_i32 s29, s25, 37
    s_lshr_b32 s29, s29, 8
    s_mul_i32 s30, s29, 7
    s_sub_u32 s30, s25, s30
    s_lshr_b32 s26, s24, 1
    s_lshl_b32 s26, s26, 2
    s_add_u32 s26, s26, s29
    s_and_b32 s27, s24, 1
    s_mul_i32 s27, s27, 7
    s_add_u32 s27, s27, s30
    s_lshl_b32 s31, s27, 8
    s_cmp_eq_u32 s27, 13
    s_cselect_b32 s31, 3200, s31
    s_waitcnt lgkmcnt(0)
    s_mov_b32 s6, 2621440
    s_mov_b32 s7, 0x00020000
    s_mov_b32 s10, 2211840
    s_mov_b32 s11, 0x00020000
    s_mov_b32 s14, 3456
    s_mov_b32 s15, 0x00020000
    s_mov_b32 s18, 10600448
    s_mov_b32 s19, 0x00020000
    s_mov_b32 s22, 2211840
    s_mov_b32 s23, 0x00020000
    s_cmp_ge_u32 s25, 28
    s_cbranch_scc1 .Lk1_retile
    s_cmp_ge_u32 s28, 4
    s_cbranch_scc1 .Lk1_producer
    s_lshr_b32 s44, s28, 1
    s_and_b32 s45, s28, 1
    s_lshl_b32 s29, s45, 7
    s_add_u32 s29, s29, s31
    v_lshlrev_b32 v31, 3, v3
    v_add_u32 v31, s29, v31
    buffer_load_dwordx2 v[32:33], v31, s[12:15], 0 offen offset:0
    buffer_load_dwordx2 v[34:35], v31, s[12:15], 0 offen offset:32
    buffer_load_dwordx2 v[36:37], v31, s[12:15], 0 offen offset:64
    buffer_load_dwordx2 v[38:39], v31, s[12:15], 0 offen offset:96
    s_lshl_b32 s29, s44, 6
    v_add_u32 v4, s29, v2
    v_lshlrev_b32 v4, 7, v4
    v_and_b32 v5, 7, v2
    v_add_u32 v6, 0, v3
    v_xor_b32 v6, v6, v5
    v_lshl_add_u32 v12, v6, 4, v4
    v_add_u32 v13, 65536, v12
    v_add_u32 v6, 4, v3
    v_xor_b32 v6, v6, v5
    v_lshl_add_u32 v14, v6, 4, v4
    v_add_u32 v15, 65536, v14
    v_and_b32 v4, 1, v3
    v_lshlrev_b32 v4, 2, v4
    v_lshrrev_b32 v5, 2, v2
    v_add_u32 v4, v4, v5
    v_lshrrev_b32 v5, 1, v3
    v_lshl_add_u32 v5, v5, 4, v4
    v_lshlrev_b32 v5, 8, v5
    v_and_b32 v6, 3, v2
    v_lshl_add_u32 v5, v6, 3, v5
    s_lshl_b32 s29, s45, 2
    v_mov_b32 v6, 0
    v_add_u32 v6, s29, v6
    v_xor_b32 v6, v6, v4
    v_lshl_add_u32 v18, v6, 5, v5
    v_add_u32 v19, 65536, v18
    v_mov_b32 v6, 1
    v_add_u32 v6, s29, v6
    v_xor_b32 v6, v6, v4
    v_lshl_add_u32 v20, v6, 5, v5
    v_add_u32 v21, 65536, v20
    v_mov_b32 v6, 2
    v_add_u32 v6, s29, v6
    v_xor_b32 v6, v6, v4
    v_lshl_add_u32 v22, v6, 5, v5
    v_add_u32 v23, 65536, v22
    v_mov_b32 v6, 3
    v_add_u32 v6, s29, v6
    v_xor_b32 v6, v6, v4
    v_lshl_add_u32 v24, v6, 5, v5
    v_add_u32 v25, 65536, v24
    v_lshlrev_b32 v30, 6, v2
    v_lshl_add_u32 v30, v3, 3, v30
    s_lshl_b32 s29, s26, 3
    s_lshl_b32 s30, s44, 2
    s_add_u32 s29, s29, s30
    s_mul_i32 s29, s29, 54
    s_lshr_b32 s30, s31, 6
    s_add_u32 s29, s29, s30
    s_lshl_b32 s30, s45, 1
    s_add_u32 s29, s29, s30
    s_lshl_b32 s40, s29, 10
    s_add_u32 s41, s40, 55296
    s_add_u32 s42, s40, 110592
    s_add_u32 s43, s40, 165888
    s_waitcnt vmcnt(0)
    v_lshlrev_b32 v40, 16, v32
    v_and_b32 v41, 0xffff0000, v32
    v_lshlrev_b32 v42, 16, v33
    v_and_b32 v43, 0xffff0000, v33
    v_lshlrev_b32 v44, 16, v34
    v_and_b32 v45, 0xffff0000, v34
    v_lshlrev_b32 v46, 16, v35
    v_and_b32 v47, 0xffff0000, v35
    v_lshlrev_b32 v48, 16, v36
    v_and_b32 v49, 0xffff0000, v36
    v_lshlrev_b32 v50, 16, v37
    v_and_b32 v51, 0xffff0000, v37
    v_lshlrev_b32 v52, 16, v38
    v_and_b32 v53, 0xffff0000, v38
    v_lshlrev_b32 v54, 16, v39
    v_and_b32 v55, 0xffff0000, v39
    s_barrier
    ds_read_b128 v[128:131], v12 offset:0
    ds_read_b128 v[132:135], v12 offset:2048
    ds_read_b128 v[136:139], v12 offset:4096
    ds_read_b128 v[140:143], v12 offset:6144
    ds_read_b64_tr_b16 v[160:161], v18 offset:16384
    ds_read_b64_tr_b16 v[162:163], v18 offset:18432
    ds_read_b64_tr_b16 v[164:165], v20 offset:16384
    ds_read_b64_tr_b16 v[166:167], v20 offset:18432
    ds_read_b64_tr_b16 v[168:169], v22 offset:16384
    ds_read_b64_tr_b16 v[170:171], v22 offset:18432
    ds_read_b64_tr_b16 v[172:173], v24 offset:16384
    ds_read_b64_tr_b16 v[174:175], v24 offset:18432
    s_waitcnt lgkmcnt(0)
    v_mfma_f32_16x16x32_bf16 v[64:67], v[160:163], v[128:131], v[40:43]
    ds_read_b128 v[144:147], v14 offset:0
    v_mfma_f32_16x16x32_bf16 v[80:83], v[160:163], v[132:135], v[40:43]
    ds_read_b128 v[148:151], v14 offset:2048
    v_mfma_f32_16x16x32_bf16 v[96:99], v[160:163], v[136:139], v[40:43]
    ds_read_b128 v[152:155], v14 offset:4096
    v_mfma_f32_16x16x32_bf16 v[112:115], v[160:163], v[140:143], v[40:43]
    ds_read_b128 v[156:159], v14 offset:6144
    v_mfma_f32_16x16x32_bf16 v[68:71], v[164:167], v[128:131], v[44:47]
    ds_read_b64_tr_b16 v[176:177], v18 offset:24576
    v_mfma_f32_16x16x32_bf16 v[84:87], v[164:167], v[132:135], v[44:47]
    ds_read_b64_tr_b16 v[178:179], v18 offset:26624
    v_mfma_f32_16x16x32_bf16 v[100:103], v[164:167], v[136:139], v[44:47]
    ds_read_b64_tr_b16 v[180:181], v20 offset:24576
    v_mfma_f32_16x16x32_bf16 v[116:119], v[164:167], v[140:143], v[44:47]
    ds_read_b64_tr_b16 v[182:183], v20 offset:26624
    v_mfma_f32_16x16x32_bf16 v[72:75], v[168:171], v[128:131], v[48:51]
    ds_read_b64_tr_b16 v[184:185], v22 offset:24576
    v_mfma_f32_16x16x32_bf16 v[88:91], v[168:171], v[132:135], v[48:51]
    ds_read_b64_tr_b16 v[186:187], v22 offset:26624
    v_mfma_f32_16x16x32_bf16 v[104:107], v[168:171], v[136:139], v[48:51]
    ds_read_b64_tr_b16 v[188:189], v24 offset:24576
    v_mfma_f32_16x16x32_bf16 v[120:123], v[168:171], v[140:143], v[48:51]
    ds_read_b64_tr_b16 v[190:191], v24 offset:26624
    v_mfma_f32_16x16x32_bf16 v[76:79], v[172:175], v[128:131], v[52:55]
    v_mfma_f32_16x16x32_bf16 v[92:95], v[172:175], v[132:135], v[52:55]
    v_mfma_f32_16x16x32_bf16 v[108:111], v[172:175], v[136:139], v[52:55]
    v_mfma_f32_16x16x32_bf16 v[124:127], v[172:175], v[140:143], v[52:55]
    s_waitcnt lgkmcnt(0)
    s_barrier
    v_mfma_f32_16x16x32_bf16 v[64:67], v[176:179], v[144:147], v[64:67]
    ds_read_b128 v[128:131], v12 offset:32768
    v_mfma_f32_16x16x32_bf16 v[80:83], v[176:179], v[148:151], v[80:83]
    ds_read_b128 v[132:135], v12 offset:34816
    v_mfma_f32_16x16x32_bf16 v[96:99], v[176:179], v[152:155], v[96:99]
    ds_read_b128 v[136:139], v12 offset:36864
    v_mfma_f32_16x16x32_bf16 v[112:115], v[176:179], v[156:159], v[112:115]
    ds_read_b128 v[140:143], v12 offset:38912
    v_mfma_f32_16x16x32_bf16 v[68:71], v[180:183], v[144:147], v[68:71]
    ds_read_b64_tr_b16 v[160:161], v18 offset:49152
    v_mfma_f32_16x16x32_bf16 v[84:87], v[180:183], v[148:151], v[84:87]
    ds_read_b64_tr_b16 v[162:163], v18 offset:51200
    v_mfma_f32_16x16x32_bf16 v[100:103], v[180:183], v[152:155], v[100:103]
    ds_read_b64_tr_b16 v[164:165], v20 offset:49152
    v_mfma_f32_16x16x32_bf16 v[116:119], v[180:183], v[156:159], v[116:119]
    ds_read_b64_tr_b16 v[166:167], v20 offset:51200
    v_mfma_f32_16x16x32_bf16 v[72:75], v[184:187], v[144:147], v[72:75]
    ds_read_b64_tr_b16 v[168:169], v22 offset:49152
    v_mfma_f32_16x16x32_bf16 v[88:91], v[184:187], v[148:151], v[88:91]
    ds_read_b64_tr_b16 v[170:171], v22 offset:51200
    v_mfma_f32_16x16x32_bf16 v[104:107], v[184:187], v[152:155], v[104:107]
    ds_read_b64_tr_b16 v[172:173], v24 offset:49152
    v_mfma_f32_16x16x32_bf16 v[120:123], v[184:187], v[156:159], v[120:123]
    ds_read_b64_tr_b16 v[174:175], v24 offset:51200
    v_mfma_f32_16x16x32_bf16 v[76:79], v[188:191], v[144:147], v[76:79]
    v_mfma_f32_16x16x32_bf16 v[92:95], v[188:191], v[148:151], v[92:95]
    v_mfma_f32_16x16x32_bf16 v[108:111], v[188:191], v[152:155], v[108:111]
    v_mfma_f32_16x16x32_bf16 v[124:127], v[188:191], v[156:159], v[124:127]
    s_waitcnt lgkmcnt(0)
    v_mfma_f32_16x16x32_bf16 v[64:67], v[160:163], v[128:131], v[64:67]
    ds_read_b128 v[144:147], v14 offset:32768
    v_mfma_f32_16x16x32_bf16 v[80:83], v[160:163], v[132:135], v[80:83]
    ds_read_b128 v[148:151], v14 offset:34816
    v_mfma_f32_16x16x32_bf16 v[96:99], v[160:163], v[136:139], v[96:99]
    ds_read_b128 v[152:155], v14 offset:36864
    v_mfma_f32_16x16x32_bf16 v[112:115], v[160:163], v[140:143], v[112:115]
    ds_read_b128 v[156:159], v14 offset:38912
    v_mfma_f32_16x16x32_bf16 v[68:71], v[164:167], v[128:131], v[68:71]
    ds_read_b64_tr_b16 v[176:177], v18 offset:57344
    v_mfma_f32_16x16x32_bf16 v[84:87], v[164:167], v[132:135], v[84:87]
    ds_read_b64_tr_b16 v[178:179], v18 offset:59392
    v_mfma_f32_16x16x32_bf16 v[100:103], v[164:167], v[136:139], v[100:103]
    ds_read_b64_tr_b16 v[180:181], v20 offset:57344
    v_mfma_f32_16x16x32_bf16 v[116:119], v[164:167], v[140:143], v[116:119]
    ds_read_b64_tr_b16 v[182:183], v20 offset:59392
    v_mfma_f32_16x16x32_bf16 v[72:75], v[168:171], v[128:131], v[72:75]
    ds_read_b64_tr_b16 v[184:185], v22 offset:57344
    v_mfma_f32_16x16x32_bf16 v[88:91], v[168:171], v[132:135], v[88:91]
    ds_read_b64_tr_b16 v[186:187], v22 offset:59392
    v_mfma_f32_16x16x32_bf16 v[104:107], v[168:171], v[136:139], v[104:107]
    ds_read_b64_tr_b16 v[188:189], v24 offset:57344
    v_mfma_f32_16x16x32_bf16 v[120:123], v[168:171], v[140:143], v[120:123]
    ds_read_b64_tr_b16 v[190:191], v24 offset:59392
    v_mfma_f32_16x16x32_bf16 v[76:79], v[172:175], v[128:131], v[76:79]
    v_mfma_f32_16x16x32_bf16 v[92:95], v[172:175], v[132:135], v[92:95]
    v_mfma_f32_16x16x32_bf16 v[108:111], v[172:175], v[136:139], v[108:111]
    v_mfma_f32_16x16x32_bf16 v[124:127], v[172:175], v[140:143], v[124:127]
    s_waitcnt lgkmcnt(0)
    s_barrier
    v_mfma_f32_16x16x32_bf16 v[64:67], v[176:179], v[144:147], v[64:67]
    ds_read_b128 v[128:131], v13 offset:0
    v_mfma_f32_16x16x32_bf16 v[80:83], v[176:179], v[148:151], v[80:83]
    ds_read_b128 v[132:135], v13 offset:2048
    v_mfma_f32_16x16x32_bf16 v[96:99], v[176:179], v[152:155], v[96:99]
    ds_read_b128 v[136:139], v13 offset:4096
    v_mfma_f32_16x16x32_bf16 v[112:115], v[176:179], v[156:159], v[112:115]
    ds_read_b128 v[140:143], v13 offset:6144
    v_mfma_f32_16x16x32_bf16 v[68:71], v[180:183], v[144:147], v[68:71]
    ds_read_b64_tr_b16 v[160:161], v19 offset:16384
    v_mfma_f32_16x16x32_bf16 v[84:87], v[180:183], v[148:151], v[84:87]
    ds_read_b64_tr_b16 v[162:163], v19 offset:18432
    v_mfma_f32_16x16x32_bf16 v[100:103], v[180:183], v[152:155], v[100:103]
    ds_read_b64_tr_b16 v[164:165], v21 offset:16384
    v_mfma_f32_16x16x32_bf16 v[116:119], v[180:183], v[156:159], v[116:119]
    ds_read_b64_tr_b16 v[166:167], v21 offset:18432
    v_mfma_f32_16x16x32_bf16 v[72:75], v[184:187], v[144:147], v[72:75]
    ds_read_b64_tr_b16 v[168:169], v23 offset:16384
    v_mfma_f32_16x16x32_bf16 v[88:91], v[184:187], v[148:151], v[88:91]
    ds_read_b64_tr_b16 v[170:171], v23 offset:18432
    v_mfma_f32_16x16x32_bf16 v[104:107], v[184:187], v[152:155], v[104:107]
    ds_read_b64_tr_b16 v[172:173], v25 offset:16384
    v_mfma_f32_16x16x32_bf16 v[120:123], v[184:187], v[156:159], v[120:123]
    ds_read_b64_tr_b16 v[174:175], v25 offset:18432
    v_mfma_f32_16x16x32_bf16 v[76:79], v[188:191], v[144:147], v[76:79]
    v_mfma_f32_16x16x32_bf16 v[92:95], v[188:191], v[148:151], v[92:95]
    v_mfma_f32_16x16x32_bf16 v[108:111], v[188:191], v[152:155], v[108:111]
    v_mfma_f32_16x16x32_bf16 v[124:127], v[188:191], v[156:159], v[124:127]
    s_waitcnt lgkmcnt(0)
    v_mfma_f32_16x16x32_bf16 v[64:67], v[160:163], v[128:131], v[64:67]
    ds_read_b128 v[144:147], v15 offset:0
    v_mfma_f32_16x16x32_bf16 v[80:83], v[160:163], v[132:135], v[80:83]
    ds_read_b128 v[148:151], v15 offset:2048
    v_mfma_f32_16x16x32_bf16 v[96:99], v[160:163], v[136:139], v[96:99]
    ds_read_b128 v[152:155], v15 offset:4096
    v_mfma_f32_16x16x32_bf16 v[112:115], v[160:163], v[140:143], v[112:115]
    ds_read_b128 v[156:159], v15 offset:6144
    v_mfma_f32_16x16x32_bf16 v[68:71], v[164:167], v[128:131], v[68:71]
    ds_read_b64_tr_b16 v[176:177], v19 offset:24576
    v_mfma_f32_16x16x32_bf16 v[84:87], v[164:167], v[132:135], v[84:87]
    ds_read_b64_tr_b16 v[178:179], v19 offset:26624
    v_mfma_f32_16x16x32_bf16 v[100:103], v[164:167], v[136:139], v[100:103]
    ds_read_b64_tr_b16 v[180:181], v21 offset:24576
    v_mfma_f32_16x16x32_bf16 v[116:119], v[164:167], v[140:143], v[116:119]
    ds_read_b64_tr_b16 v[182:183], v21 offset:26624
    v_mfma_f32_16x16x32_bf16 v[72:75], v[168:171], v[128:131], v[72:75]
    ds_read_b64_tr_b16 v[184:185], v23 offset:24576
    v_mfma_f32_16x16x32_bf16 v[88:91], v[168:171], v[132:135], v[88:91]
    ds_read_b64_tr_b16 v[186:187], v23 offset:26624
    v_mfma_f32_16x16x32_bf16 v[104:107], v[168:171], v[136:139], v[104:107]
    ds_read_b64_tr_b16 v[188:189], v25 offset:24576
    v_mfma_f32_16x16x32_bf16 v[120:123], v[168:171], v[140:143], v[120:123]
    ds_read_b64_tr_b16 v[190:191], v25 offset:26624
    v_mfma_f32_16x16x32_bf16 v[76:79], v[172:175], v[128:131], v[76:79]
    v_mfma_f32_16x16x32_bf16 v[92:95], v[172:175], v[132:135], v[92:95]
    v_mfma_f32_16x16x32_bf16 v[108:111], v[172:175], v[136:139], v[108:111]
    v_mfma_f32_16x16x32_bf16 v[124:127], v[172:175], v[140:143], v[124:127]
    s_waitcnt lgkmcnt(0)
    s_barrier
    v_mfma_f32_16x16x32_bf16 v[64:67], v[176:179], v[144:147], v[64:67]
    ds_read_b128 v[128:131], v13 offset:32768
    v_mfma_f32_16x16x32_bf16 v[80:83], v[176:179], v[148:151], v[80:83]
    ds_read_b128 v[132:135], v13 offset:34816
    v_mfma_f32_16x16x32_bf16 v[96:99], v[176:179], v[152:155], v[96:99]
    ds_read_b128 v[136:139], v13 offset:36864
    v_mfma_f32_16x16x32_bf16 v[112:115], v[176:179], v[156:159], v[112:115]
    ds_read_b128 v[140:143], v13 offset:38912
    v_mfma_f32_16x16x32_bf16 v[68:71], v[180:183], v[144:147], v[68:71]
    ds_read_b64_tr_b16 v[160:161], v19 offset:49152
    v_mfma_f32_16x16x32_bf16 v[84:87], v[180:183], v[148:151], v[84:87]
    ds_read_b64_tr_b16 v[162:163], v19 offset:51200
    v_mfma_f32_16x16x32_bf16 v[100:103], v[180:183], v[152:155], v[100:103]
    ds_read_b64_tr_b16 v[164:165], v21 offset:49152
    v_mfma_f32_16x16x32_bf16 v[116:119], v[180:183], v[156:159], v[116:119]
    ds_read_b64_tr_b16 v[166:167], v21 offset:51200
    v_mfma_f32_16x16x32_bf16 v[72:75], v[184:187], v[144:147], v[72:75]
    ds_read_b64_tr_b16 v[168:169], v23 offset:49152
    v_mfma_f32_16x16x32_bf16 v[88:91], v[184:187], v[148:151], v[88:91]
    ds_read_b64_tr_b16 v[170:171], v23 offset:51200
    v_mfma_f32_16x16x32_bf16 v[104:107], v[184:187], v[152:155], v[104:107]
    ds_read_b64_tr_b16 v[172:173], v25 offset:49152
    v_mfma_f32_16x16x32_bf16 v[120:123], v[184:187], v[156:159], v[120:123]
    ds_read_b64_tr_b16 v[174:175], v25 offset:51200
    v_mfma_f32_16x16x32_bf16 v[76:79], v[188:191], v[144:147], v[76:79]
    v_mfma_f32_16x16x32_bf16 v[92:95], v[188:191], v[148:151], v[92:95]
    v_mfma_f32_16x16x32_bf16 v[108:111], v[188:191], v[152:155], v[108:111]
    v_mfma_f32_16x16x32_bf16 v[124:127], v[188:191], v[156:159], v[124:127]
    s_waitcnt lgkmcnt(0)
    v_mfma_f32_16x16x32_bf16 v[64:67], v[160:163], v[128:131], v[64:67]
    ds_read_b128 v[144:147], v15 offset:32768
    v_mfma_f32_16x16x32_bf16 v[80:83], v[160:163], v[132:135], v[80:83]
    ds_read_b128 v[148:151], v15 offset:34816
    v_mfma_f32_16x16x32_bf16 v[96:99], v[160:163], v[136:139], v[96:99]
    ds_read_b128 v[152:155], v15 offset:36864
    v_mfma_f32_16x16x32_bf16 v[112:115], v[160:163], v[140:143], v[112:115]
    ds_read_b128 v[156:159], v15 offset:38912
    v_mfma_f32_16x16x32_bf16 v[68:71], v[164:167], v[128:131], v[68:71]
    ds_read_b64_tr_b16 v[176:177], v19 offset:57344
    v_mfma_f32_16x16x32_bf16 v[84:87], v[164:167], v[132:135], v[84:87]
    ds_read_b64_tr_b16 v[178:179], v19 offset:59392
    v_mfma_f32_16x16x32_bf16 v[100:103], v[164:167], v[136:139], v[100:103]
    ds_read_b64_tr_b16 v[180:181], v21 offset:57344
    v_mfma_f32_16x16x32_bf16 v[116:119], v[164:167], v[140:143], v[116:119]
    ds_read_b64_tr_b16 v[182:183], v21 offset:59392
    v_mfma_f32_16x16x32_bf16 v[72:75], v[168:171], v[128:131], v[72:75]
    ds_read_b64_tr_b16 v[184:185], v23 offset:57344
    v_mfma_f32_16x16x32_bf16 v[88:91], v[168:171], v[132:135], v[88:91]
    ds_read_b64_tr_b16 v[186:187], v23 offset:59392
    v_mfma_f32_16x16x32_bf16 v[104:107], v[168:171], v[136:139], v[104:107]
    ds_read_b64_tr_b16 v[188:189], v25 offset:57344
    v_mfma_f32_16x16x32_bf16 v[120:123], v[168:171], v[140:143], v[120:123]
    ds_read_b64_tr_b16 v[190:191], v25 offset:59392
    v_mfma_f32_16x16x32_bf16 v[76:79], v[172:175], v[128:131], v[76:79]
    v_mfma_f32_16x16x32_bf16 v[92:95], v[172:175], v[132:135], v[92:95]
    v_mfma_f32_16x16x32_bf16 v[108:111], v[172:175], v[136:139], v[108:111]
    v_mfma_f32_16x16x32_bf16 v[124:127], v[172:175], v[140:143], v[124:127]
    s_waitcnt lgkmcnt(0)
    s_barrier
    v_mfma_f32_16x16x32_bf16 v[64:67], v[176:179], v[144:147], v[64:67]
    ds_read_b128 v[128:131], v12 offset:0
    v_mfma_f32_16x16x32_bf16 v[80:83], v[176:179], v[148:151], v[80:83]
    ds_read_b128 v[132:135], v12 offset:2048
    v_mfma_f32_16x16x32_bf16 v[96:99], v[176:179], v[152:155], v[96:99]
    ds_read_b128 v[136:139], v12 offset:4096
    v_mfma_f32_16x16x32_bf16 v[112:115], v[176:179], v[156:159], v[112:115]
    ds_read_b128 v[140:143], v12 offset:6144
    v_mfma_f32_16x16x32_bf16 v[68:71], v[180:183], v[144:147], v[68:71]
    ds_read_b64_tr_b16 v[160:161], v18 offset:16384
    v_mfma_f32_16x16x32_bf16 v[84:87], v[180:183], v[148:151], v[84:87]
    ds_read_b64_tr_b16 v[162:163], v18 offset:18432
    v_mfma_f32_16x16x32_bf16 v[100:103], v[180:183], v[152:155], v[100:103]
    ds_read_b64_tr_b16 v[164:165], v20 offset:16384
    v_mfma_f32_16x16x32_bf16 v[116:119], v[180:183], v[156:159], v[116:119]
    ds_read_b64_tr_b16 v[166:167], v20 offset:18432
    v_mfma_f32_16x16x32_bf16 v[72:75], v[184:187], v[144:147], v[72:75]
    ds_read_b64_tr_b16 v[168:169], v22 offset:16384
    v_mfma_f32_16x16x32_bf16 v[88:91], v[184:187], v[148:151], v[88:91]
    ds_read_b64_tr_b16 v[170:171], v22 offset:18432
    v_mfma_f32_16x16x32_bf16 v[104:107], v[184:187], v[152:155], v[104:107]
    ds_read_b64_tr_b16 v[172:173], v24 offset:16384
    v_mfma_f32_16x16x32_bf16 v[120:123], v[184:187], v[156:159], v[120:123]
    ds_read_b64_tr_b16 v[174:175], v24 offset:18432
    v_mfma_f32_16x16x32_bf16 v[76:79], v[188:191], v[144:147], v[76:79]
    v_mfma_f32_16x16x32_bf16 v[92:95], v[188:191], v[148:151], v[92:95]
    v_mfma_f32_16x16x32_bf16 v[108:111], v[188:191], v[152:155], v[108:111]
    v_mfma_f32_16x16x32_bf16 v[124:127], v[188:191], v[156:159], v[124:127]
    s_waitcnt lgkmcnt(0)
    v_mfma_f32_16x16x32_bf16 v[64:67], v[160:163], v[128:131], v[64:67]
    ds_read_b128 v[144:147], v14 offset:0
    v_mfma_f32_16x16x32_bf16 v[80:83], v[160:163], v[132:135], v[80:83]
    ds_read_b128 v[148:151], v14 offset:2048
    v_mfma_f32_16x16x32_bf16 v[96:99], v[160:163], v[136:139], v[96:99]
    ds_read_b128 v[152:155], v14 offset:4096
    v_mfma_f32_16x16x32_bf16 v[112:115], v[160:163], v[140:143], v[112:115]
    ds_read_b128 v[156:159], v14 offset:6144
    v_mfma_f32_16x16x32_bf16 v[68:71], v[164:167], v[128:131], v[68:71]
    ds_read_b64_tr_b16 v[176:177], v18 offset:24576
    v_mfma_f32_16x16x32_bf16 v[84:87], v[164:167], v[132:135], v[84:87]
    ds_read_b64_tr_b16 v[178:179], v18 offset:26624
    v_mfma_f32_16x16x32_bf16 v[100:103], v[164:167], v[136:139], v[100:103]
    ds_read_b64_tr_b16 v[180:181], v20 offset:24576
    v_mfma_f32_16x16x32_bf16 v[116:119], v[164:167], v[140:143], v[116:119]
    ds_read_b64_tr_b16 v[182:183], v20 offset:26624
    v_mfma_f32_16x16x32_bf16 v[72:75], v[168:171], v[128:131], v[72:75]
    ds_read_b64_tr_b16 v[184:185], v22 offset:24576
    v_mfma_f32_16x16x32_bf16 v[88:91], v[168:171], v[132:135], v[88:91]
    ds_read_b64_tr_b16 v[186:187], v22 offset:26624
    v_mfma_f32_16x16x32_bf16 v[104:107], v[168:171], v[136:139], v[104:107]
    ds_read_b64_tr_b16 v[188:189], v24 offset:24576
    v_mfma_f32_16x16x32_bf16 v[120:123], v[168:171], v[140:143], v[120:123]
    ds_read_b64_tr_b16 v[190:191], v24 offset:26624
    v_mfma_f32_16x16x32_bf16 v[76:79], v[172:175], v[128:131], v[76:79]
    v_mfma_f32_16x16x32_bf16 v[92:95], v[172:175], v[132:135], v[92:95]
    v_mfma_f32_16x16x32_bf16 v[108:111], v[172:175], v[136:139], v[108:111]
    v_mfma_f32_16x16x32_bf16 v[124:127], v[172:175], v[140:143], v[124:127]
    s_waitcnt lgkmcnt(0)
    s_barrier
    v_mfma_f32_16x16x32_bf16 v[64:67], v[176:179], v[144:147], v[64:67]
    ds_read_b128 v[128:131], v12 offset:32768
    v_mfma_f32_16x16x32_bf16 v[80:83], v[176:179], v[148:151], v[80:83]
    ds_read_b128 v[132:135], v12 offset:34816
    v_mfma_f32_16x16x32_bf16 v[96:99], v[176:179], v[152:155], v[96:99]
    ds_read_b128 v[136:139], v12 offset:36864
    v_mfma_f32_16x16x32_bf16 v[112:115], v[176:179], v[156:159], v[112:115]
    ds_read_b128 v[140:143], v12 offset:38912
    v_mfma_f32_16x16x32_bf16 v[68:71], v[180:183], v[144:147], v[68:71]
    ds_read_b64_tr_b16 v[160:161], v18 offset:49152
    v_mfma_f32_16x16x32_bf16 v[84:87], v[180:183], v[148:151], v[84:87]
    ds_read_b64_tr_b16 v[162:163], v18 offset:51200
    v_mfma_f32_16x16x32_bf16 v[100:103], v[180:183], v[152:155], v[100:103]
    ds_read_b64_tr_b16 v[164:165], v20 offset:49152
    v_mfma_f32_16x16x32_bf16 v[116:119], v[180:183], v[156:159], v[116:119]
    ds_read_b64_tr_b16 v[166:167], v20 offset:51200
    v_mfma_f32_16x16x32_bf16 v[72:75], v[184:187], v[144:147], v[72:75]
    ds_read_b64_tr_b16 v[168:169], v22 offset:49152
    v_mfma_f32_16x16x32_bf16 v[88:91], v[184:187], v[148:151], v[88:91]
    ds_read_b64_tr_b16 v[170:171], v22 offset:51200
    v_mfma_f32_16x16x32_bf16 v[104:107], v[184:187], v[152:155], v[104:107]
    ds_read_b64_tr_b16 v[172:173], v24 offset:49152
    v_mfma_f32_16x16x32_bf16 v[120:123], v[184:187], v[156:159], v[120:123]
    ds_read_b64_tr_b16 v[174:175], v24 offset:51200
    v_mfma_f32_16x16x32_bf16 v[76:79], v[188:191], v[144:147], v[76:79]
    v_mfma_f32_16x16x32_bf16 v[92:95], v[188:191], v[148:151], v[92:95]
    v_mfma_f32_16x16x32_bf16 v[108:111], v[188:191], v[152:155], v[108:111]
    v_mfma_f32_16x16x32_bf16 v[124:127], v[188:191], v[156:159], v[124:127]
    s_waitcnt lgkmcnt(0)
    v_mfma_f32_16x16x32_bf16 v[64:67], v[160:163], v[128:131], v[64:67]
    ds_read_b128 v[144:147], v14 offset:32768
    v_mfma_f32_16x16x32_bf16 v[80:83], v[160:163], v[132:135], v[80:83]
    ds_read_b128 v[148:151], v14 offset:34816
    v_mfma_f32_16x16x32_bf16 v[96:99], v[160:163], v[136:139], v[96:99]
    ds_read_b128 v[152:155], v14 offset:36864
    v_mfma_f32_16x16x32_bf16 v[112:115], v[160:163], v[140:143], v[112:115]
    ds_read_b128 v[156:159], v14 offset:38912
    v_mfma_f32_16x16x32_bf16 v[68:71], v[164:167], v[128:131], v[68:71]
    ds_read_b64_tr_b16 v[176:177], v18 offset:57344
    v_mfma_f32_16x16x32_bf16 v[84:87], v[164:167], v[132:135], v[84:87]
    ds_read_b64_tr_b16 v[178:179], v18 offset:59392
    v_mfma_f32_16x16x32_bf16 v[100:103], v[164:167], v[136:139], v[100:103]
    ds_read_b64_tr_b16 v[180:181], v20 offset:57344
    v_mfma_f32_16x16x32_bf16 v[116:119], v[164:167], v[140:143], v[116:119]
    ds_read_b64_tr_b16 v[182:183], v20 offset:59392
    v_mfma_f32_16x16x32_bf16 v[72:75], v[168:171], v[128:131], v[72:75]
    ds_read_b64_tr_b16 v[184:185], v22 offset:57344
    v_mfma_f32_16x16x32_bf16 v[88:91], v[168:171], v[132:135], v[88:91]
    ds_read_b64_tr_b16 v[186:187], v22 offset:59392
    v_mfma_f32_16x16x32_bf16 v[104:107], v[168:171], v[136:139], v[104:107]
    ds_read_b64_tr_b16 v[188:189], v24 offset:57344
    v_mfma_f32_16x16x32_bf16 v[120:123], v[168:171], v[140:143], v[120:123]
    ds_read_b64_tr_b16 v[190:191], v24 offset:59392
    v_mfma_f32_16x16x32_bf16 v[76:79], v[172:175], v[128:131], v[76:79]
    v_mfma_f32_16x16x32_bf16 v[92:95], v[172:175], v[132:135], v[92:95]
    v_mfma_f32_16x16x32_bf16 v[108:111], v[172:175], v[136:139], v[108:111]
    v_mfma_f32_16x16x32_bf16 v[124:127], v[172:175], v[140:143], v[124:127]
    s_waitcnt lgkmcnt(0)
    s_barrier
    v_mfma_f32_16x16x32_bf16 v[64:67], v[176:179], v[144:147], v[64:67]
    ds_read_b128 v[128:131], v13 offset:0
    v_mfma_f32_16x16x32_bf16 v[80:83], v[176:179], v[148:151], v[80:83]
    ds_read_b128 v[132:135], v13 offset:2048
    v_mfma_f32_16x16x32_bf16 v[96:99], v[176:179], v[152:155], v[96:99]
    ds_read_b128 v[136:139], v13 offset:4096
    v_mfma_f32_16x16x32_bf16 v[112:115], v[176:179], v[156:159], v[112:115]
    ds_read_b128 v[140:143], v13 offset:6144
    v_mfma_f32_16x16x32_bf16 v[68:71], v[180:183], v[144:147], v[68:71]
    ds_read_b64_tr_b16 v[160:161], v19 offset:16384
    v_mfma_f32_16x16x32_bf16 v[84:87], v[180:183], v[148:151], v[84:87]
    ds_read_b64_tr_b16 v[162:163], v19 offset:18432
    v_mfma_f32_16x16x32_bf16 v[100:103], v[180:183], v[152:155], v[100:103]
    ds_read_b64_tr_b16 v[164:165], v21 offset:16384
    v_mfma_f32_16x16x32_bf16 v[116:119], v[180:183], v[156:159], v[116:119]
    ds_read_b64_tr_b16 v[166:167], v21 offset:18432
    v_mfma_f32_16x16x32_bf16 v[72:75], v[184:187], v[144:147], v[72:75]
    ds_read_b64_tr_b16 v[168:169], v23 offset:16384
    v_mfma_f32_16x16x32_bf16 v[88:91], v[184:187], v[148:151], v[88:91]
    ds_read_b64_tr_b16 v[170:171], v23 offset:18432
    v_mfma_f32_16x16x32_bf16 v[104:107], v[184:187], v[152:155], v[104:107]
    ds_read_b64_tr_b16 v[172:173], v25 offset:16384
    v_mfma_f32_16x16x32_bf16 v[120:123], v[184:187], v[156:159], v[120:123]
    ds_read_b64_tr_b16 v[174:175], v25 offset:18432
    v_mfma_f32_16x16x32_bf16 v[76:79], v[188:191], v[144:147], v[76:79]
    v_mfma_f32_16x16x32_bf16 v[92:95], v[188:191], v[148:151], v[92:95]
    v_mfma_f32_16x16x32_bf16 v[108:111], v[188:191], v[152:155], v[108:111]
    v_mfma_f32_16x16x32_bf16 v[124:127], v[188:191], v[156:159], v[124:127]
    s_waitcnt lgkmcnt(0)
    v_mfma_f32_16x16x32_bf16 v[64:67], v[160:163], v[128:131], v[64:67]
    ds_read_b128 v[144:147], v15 offset:0
    v_mfma_f32_16x16x32_bf16 v[80:83], v[160:163], v[132:135], v[80:83]
    ds_read_b128 v[148:151], v15 offset:2048
    v_mfma_f32_16x16x32_bf16 v[96:99], v[160:163], v[136:139], v[96:99]
    ds_read_b128 v[152:155], v15 offset:4096
    v_mfma_f32_16x16x32_bf16 v[112:115], v[160:163], v[140:143], v[112:115]
    ds_read_b128 v[156:159], v15 offset:6144
    v_mfma_f32_16x16x32_bf16 v[68:71], v[164:167], v[128:131], v[68:71]
    ds_read_b64_tr_b16 v[176:177], v19 offset:24576
    v_mfma_f32_16x16x32_bf16 v[84:87], v[164:167], v[132:135], v[84:87]
    ds_read_b64_tr_b16 v[178:179], v19 offset:26624
    v_mfma_f32_16x16x32_bf16 v[100:103], v[164:167], v[136:139], v[100:103]
    ds_read_b64_tr_b16 v[180:181], v21 offset:24576
    v_mfma_f32_16x16x32_bf16 v[116:119], v[164:167], v[140:143], v[116:119]
    ds_read_b64_tr_b16 v[182:183], v21 offset:26624
    v_mfma_f32_16x16x32_bf16 v[72:75], v[168:171], v[128:131], v[72:75]
    ds_read_b64_tr_b16 v[184:185], v23 offset:24576
    v_mfma_f32_16x16x32_bf16 v[88:91], v[168:171], v[132:135], v[88:91]
    ds_read_b64_tr_b16 v[186:187], v23 offset:26624
    v_mfma_f32_16x16x32_bf16 v[104:107], v[168:171], v[136:139], v[104:107]
    ds_read_b64_tr_b16 v[188:189], v25 offset:24576
    v_mfma_f32_16x16x32_bf16 v[120:123], v[168:171], v[140:143], v[120:123]
    ds_read_b64_tr_b16 v[190:191], v25 offset:26624
    v_mfma_f32_16x16x32_bf16 v[76:79], v[172:175], v[128:131], v[76:79]
    v_mfma_f32_16x16x32_bf16 v[92:95], v[172:175], v[132:135], v[92:95]
    v_mfma_f32_16x16x32_bf16 v[108:111], v[172:175], v[136:139], v[108:111]
    v_mfma_f32_16x16x32_bf16 v[124:127], v[172:175], v[140:143], v[124:127]
    s_waitcnt lgkmcnt(0)
    s_barrier
    v_mfma_f32_16x16x32_bf16 v[64:67], v[176:179], v[144:147], v[64:67]
    ds_read_b128 v[128:131], v13 offset:32768
    v_mfma_f32_16x16x32_bf16 v[80:83], v[176:179], v[148:151], v[80:83]
    ds_read_b128 v[132:135], v13 offset:34816
    v_mfma_f32_16x16x32_bf16 v[96:99], v[176:179], v[152:155], v[96:99]
    ds_read_b128 v[136:139], v13 offset:36864
    v_mfma_f32_16x16x32_bf16 v[112:115], v[176:179], v[156:159], v[112:115]
    ds_read_b128 v[140:143], v13 offset:38912
    v_mfma_f32_16x16x32_bf16 v[68:71], v[180:183], v[144:147], v[68:71]
    ds_read_b64_tr_b16 v[160:161], v19 offset:49152
    v_mfma_f32_16x16x32_bf16 v[84:87], v[180:183], v[148:151], v[84:87]
    ds_read_b64_tr_b16 v[162:163], v19 offset:51200
    v_mfma_f32_16x16x32_bf16 v[100:103], v[180:183], v[152:155], v[100:103]
    ds_read_b64_tr_b16 v[164:165], v21 offset:49152
    v_mfma_f32_16x16x32_bf16 v[116:119], v[180:183], v[156:159], v[116:119]
    ds_read_b64_tr_b16 v[166:167], v21 offset:51200
    v_mfma_f32_16x16x32_bf16 v[72:75], v[184:187], v[144:147], v[72:75]
    ds_read_b64_tr_b16 v[168:169], v23 offset:49152
    v_mfma_f32_16x16x32_bf16 v[88:91], v[184:187], v[148:151], v[88:91]
    ds_read_b64_tr_b16 v[170:171], v23 offset:51200
    v_mfma_f32_16x16x32_bf16 v[104:107], v[184:187], v[152:155], v[104:107]
    ds_read_b64_tr_b16 v[172:173], v25 offset:49152
    v_mfma_f32_16x16x32_bf16 v[120:123], v[184:187], v[156:159], v[120:123]
    ds_read_b64_tr_b16 v[174:175], v25 offset:51200
    v_mfma_f32_16x16x32_bf16 v[76:79], v[188:191], v[144:147], v[76:79]
    v_mfma_f32_16x16x32_bf16 v[92:95], v[188:191], v[148:151], v[92:95]
    v_mfma_f32_16x16x32_bf16 v[108:111], v[188:191], v[152:155], v[108:111]
    v_mfma_f32_16x16x32_bf16 v[124:127], v[188:191], v[156:159], v[124:127]
    s_waitcnt lgkmcnt(0)
    v_mfma_f32_16x16x32_bf16 v[64:67], v[160:163], v[128:131], v[64:67]
    ds_read_b128 v[144:147], v15 offset:32768
    v_mfma_f32_16x16x32_bf16 v[80:83], v[160:163], v[132:135], v[80:83]
    ds_read_b128 v[148:151], v15 offset:34816
    v_mfma_f32_16x16x32_bf16 v[96:99], v[160:163], v[136:139], v[96:99]
    ds_read_b128 v[152:155], v15 offset:36864
    v_mfma_f32_16x16x32_bf16 v[112:115], v[160:163], v[140:143], v[112:115]
    ds_read_b128 v[156:159], v15 offset:38912
    v_mfma_f32_16x16x32_bf16 v[68:71], v[164:167], v[128:131], v[68:71]
    ds_read_b64_tr_b16 v[176:177], v19 offset:57344
    v_mfma_f32_16x16x32_bf16 v[84:87], v[164:167], v[132:135], v[84:87]
    ds_read_b64_tr_b16 v[178:179], v19 offset:59392
    v_mfma_f32_16x16x32_bf16 v[100:103], v[164:167], v[136:139], v[100:103]
    ds_read_b64_tr_b16 v[180:181], v21 offset:57344
    v_mfma_f32_16x16x32_bf16 v[116:119], v[164:167], v[140:143], v[116:119]
    ds_read_b64_tr_b16 v[182:183], v21 offset:59392
    v_mfma_f32_16x16x32_bf16 v[72:75], v[168:171], v[128:131], v[72:75]
    ds_read_b64_tr_b16 v[184:185], v23 offset:57344
    v_mfma_f32_16x16x32_bf16 v[88:91], v[168:171], v[132:135], v[88:91]
    ds_read_b64_tr_b16 v[186:187], v23 offset:59392
    v_mfma_f32_16x16x32_bf16 v[104:107], v[168:171], v[136:139], v[104:107]
    ds_read_b64_tr_b16 v[188:189], v25 offset:57344
    v_mfma_f32_16x16x32_bf16 v[120:123], v[168:171], v[140:143], v[120:123]
    ds_read_b64_tr_b16 v[190:191], v25 offset:59392
    v_mfma_f32_16x16x32_bf16 v[76:79], v[172:175], v[128:131], v[76:79]
    v_mfma_f32_16x16x32_bf16 v[92:95], v[172:175], v[132:135], v[92:95]
    v_mfma_f32_16x16x32_bf16 v[108:111], v[172:175], v[136:139], v[108:111]
    v_mfma_f32_16x16x32_bf16 v[124:127], v[172:175], v[140:143], v[124:127]
    s_waitcnt lgkmcnt(0)
    s_barrier
    v_mfma_f32_16x16x32_bf16 v[64:67], v[176:179], v[144:147], v[64:67]
    ds_read_b128 v[128:131], v12 offset:0
    v_mfma_f32_16x16x32_bf16 v[80:83], v[176:179], v[148:151], v[80:83]
    ds_read_b128 v[132:135], v12 offset:2048
    v_mfma_f32_16x16x32_bf16 v[96:99], v[176:179], v[152:155], v[96:99]
    ds_read_b128 v[136:139], v12 offset:4096
    v_mfma_f32_16x16x32_bf16 v[112:115], v[176:179], v[156:159], v[112:115]
    ds_read_b128 v[140:143], v12 offset:6144
    v_mfma_f32_16x16x32_bf16 v[68:71], v[180:183], v[144:147], v[68:71]
    ds_read_b64_tr_b16 v[160:161], v18 offset:16384
    v_mfma_f32_16x16x32_bf16 v[84:87], v[180:183], v[148:151], v[84:87]
    ds_read_b64_tr_b16 v[162:163], v18 offset:18432
    v_mfma_f32_16x16x32_bf16 v[100:103], v[180:183], v[152:155], v[100:103]
    ds_read_b64_tr_b16 v[164:165], v20 offset:16384
    v_mfma_f32_16x16x32_bf16 v[116:119], v[180:183], v[156:159], v[116:119]
    ds_read_b64_tr_b16 v[166:167], v20 offset:18432
    v_mfma_f32_16x16x32_bf16 v[72:75], v[184:187], v[144:147], v[72:75]
    ds_read_b64_tr_b16 v[168:169], v22 offset:16384
    v_mfma_f32_16x16x32_bf16 v[88:91], v[184:187], v[148:151], v[88:91]
    ds_read_b64_tr_b16 v[170:171], v22 offset:18432
    v_mfma_f32_16x16x32_bf16 v[104:107], v[184:187], v[152:155], v[104:107]
    ds_read_b64_tr_b16 v[172:173], v24 offset:16384
    v_mfma_f32_16x16x32_bf16 v[120:123], v[184:187], v[156:159], v[120:123]
    ds_read_b64_tr_b16 v[174:175], v24 offset:18432
    v_mfma_f32_16x16x32_bf16 v[76:79], v[188:191], v[144:147], v[76:79]
    v_mfma_f32_16x16x32_bf16 v[92:95], v[188:191], v[148:151], v[92:95]
    v_mfma_f32_16x16x32_bf16 v[108:111], v[188:191], v[152:155], v[108:111]
    v_mfma_f32_16x16x32_bf16 v[124:127], v[188:191], v[156:159], v[124:127]
    s_waitcnt lgkmcnt(0)
    v_mfma_f32_16x16x32_bf16 v[64:67], v[160:163], v[128:131], v[64:67]
    ds_read_b128 v[144:147], v14 offset:0
    v_mfma_f32_16x16x32_bf16 v[80:83], v[160:163], v[132:135], v[80:83]
    ds_read_b128 v[148:151], v14 offset:2048
    v_mfma_f32_16x16x32_bf16 v[96:99], v[160:163], v[136:139], v[96:99]
    ds_read_b128 v[152:155], v14 offset:4096
    v_mfma_f32_16x16x32_bf16 v[112:115], v[160:163], v[140:143], v[112:115]
    ds_read_b128 v[156:159], v14 offset:6144
    v_mfma_f32_16x16x32_bf16 v[68:71], v[164:167], v[128:131], v[68:71]
    ds_read_b64_tr_b16 v[176:177], v18 offset:24576
    v_mfma_f32_16x16x32_bf16 v[84:87], v[164:167], v[132:135], v[84:87]
    ds_read_b64_tr_b16 v[178:179], v18 offset:26624
    v_mfma_f32_16x16x32_bf16 v[100:103], v[164:167], v[136:139], v[100:103]
    ds_read_b64_tr_b16 v[180:181], v20 offset:24576
    v_mfma_f32_16x16x32_bf16 v[116:119], v[164:167], v[140:143], v[116:119]
    ds_read_b64_tr_b16 v[182:183], v20 offset:26624
    v_mfma_f32_16x16x32_bf16 v[72:75], v[168:171], v[128:131], v[72:75]
    ds_read_b64_tr_b16 v[184:185], v22 offset:24576
    v_mfma_f32_16x16x32_bf16 v[88:91], v[168:171], v[132:135], v[88:91]
    ds_read_b64_tr_b16 v[186:187], v22 offset:26624
    v_mfma_f32_16x16x32_bf16 v[104:107], v[168:171], v[136:139], v[104:107]
    ds_read_b64_tr_b16 v[188:189], v24 offset:24576
    v_mfma_f32_16x16x32_bf16 v[120:123], v[168:171], v[140:143], v[120:123]
    ds_read_b64_tr_b16 v[190:191], v24 offset:26624
    v_mfma_f32_16x16x32_bf16 v[76:79], v[172:175], v[128:131], v[76:79]
    v_mfma_f32_16x16x32_bf16 v[92:95], v[172:175], v[132:135], v[92:95]
    v_mfma_f32_16x16x32_bf16 v[108:111], v[172:175], v[136:139], v[108:111]
    v_mfma_f32_16x16x32_bf16 v[124:127], v[172:175], v[140:143], v[124:127]
    s_waitcnt lgkmcnt(0)
    s_barrier
    v_mfma_f32_16x16x32_bf16 v[64:67], v[176:179], v[144:147], v[64:67]
    ds_read_b128 v[128:131], v12 offset:32768
    v_mfma_f32_16x16x32_bf16 v[80:83], v[176:179], v[148:151], v[80:83]
    ds_read_b128 v[132:135], v12 offset:34816
    v_mfma_f32_16x16x32_bf16 v[96:99], v[176:179], v[152:155], v[96:99]
    ds_read_b128 v[136:139], v12 offset:36864
    v_mfma_f32_16x16x32_bf16 v[112:115], v[176:179], v[156:159], v[112:115]
    ds_read_b128 v[140:143], v12 offset:38912
    v_mfma_f32_16x16x32_bf16 v[68:71], v[180:183], v[144:147], v[68:71]
    ds_read_b64_tr_b16 v[160:161], v18 offset:49152
    v_mfma_f32_16x16x32_bf16 v[84:87], v[180:183], v[148:151], v[84:87]
    ds_read_b64_tr_b16 v[162:163], v18 offset:51200
    v_mfma_f32_16x16x32_bf16 v[100:103], v[180:183], v[152:155], v[100:103]
    ds_read_b64_tr_b16 v[164:165], v20 offset:49152
    v_mfma_f32_16x16x32_bf16 v[116:119], v[180:183], v[156:159], v[116:119]
    ds_read_b64_tr_b16 v[166:167], v20 offset:51200
    v_mfma_f32_16x16x32_bf16 v[72:75], v[184:187], v[144:147], v[72:75]
    ds_read_b64_tr_b16 v[168:169], v22 offset:49152
    v_mfma_f32_16x16x32_bf16 v[88:91], v[184:187], v[148:151], v[88:91]
    ds_read_b64_tr_b16 v[170:171], v22 offset:51200
    v_mfma_f32_16x16x32_bf16 v[104:107], v[184:187], v[152:155], v[104:107]
    ds_read_b64_tr_b16 v[172:173], v24 offset:49152
    v_mfma_f32_16x16x32_bf16 v[120:123], v[184:187], v[156:159], v[120:123]
    ds_read_b64_tr_b16 v[174:175], v24 offset:51200
    v_mfma_f32_16x16x32_bf16 v[76:79], v[188:191], v[144:147], v[76:79]
    v_mfma_f32_16x16x32_bf16 v[92:95], v[188:191], v[148:151], v[92:95]
    v_mfma_f32_16x16x32_bf16 v[108:111], v[188:191], v[152:155], v[108:111]
    v_mfma_f32_16x16x32_bf16 v[124:127], v[188:191], v[156:159], v[124:127]
    s_waitcnt lgkmcnt(0)
    v_mfma_f32_16x16x32_bf16 v[64:67], v[160:163], v[128:131], v[64:67]
    ds_read_b128 v[144:147], v14 offset:32768
    v_mfma_f32_16x16x32_bf16 v[80:83], v[160:163], v[132:135], v[80:83]
    ds_read_b128 v[148:151], v14 offset:34816
    v_mfma_f32_16x16x32_bf16 v[96:99], v[160:163], v[136:139], v[96:99]
    ds_read_b128 v[152:155], v14 offset:36864
    v_mfma_f32_16x16x32_bf16 v[112:115], v[160:163], v[140:143], v[112:115]
    ds_read_b128 v[156:159], v14 offset:38912
    v_mfma_f32_16x16x32_bf16 v[68:71], v[164:167], v[128:131], v[68:71]
    ds_read_b64_tr_b16 v[176:177], v18 offset:57344
    v_mfma_f32_16x16x32_bf16 v[84:87], v[164:167], v[132:135], v[84:87]
    ds_read_b64_tr_b16 v[178:179], v18 offset:59392
    v_mfma_f32_16x16x32_bf16 v[100:103], v[164:167], v[136:139], v[100:103]
    ds_read_b64_tr_b16 v[180:181], v20 offset:57344
    v_mfma_f32_16x16x32_bf16 v[116:119], v[164:167], v[140:143], v[116:119]
    ds_read_b64_tr_b16 v[182:183], v20 offset:59392
    v_mfma_f32_16x16x32_bf16 v[72:75], v[168:171], v[128:131], v[72:75]
    ds_read_b64_tr_b16 v[184:185], v22 offset:57344
    v_mfma_f32_16x16x32_bf16 v[88:91], v[168:171], v[132:135], v[88:91]
    ds_read_b64_tr_b16 v[186:187], v22 offset:59392
    v_mfma_f32_16x16x32_bf16 v[104:107], v[168:171], v[136:139], v[104:107]
    ds_read_b64_tr_b16 v[188:189], v24 offset:57344
    v_mfma_f32_16x16x32_bf16 v[120:123], v[168:171], v[140:143], v[120:123]
    ds_read_b64_tr_b16 v[190:191], v24 offset:59392
    v_mfma_f32_16x16x32_bf16 v[76:79], v[172:175], v[128:131], v[76:79]
    v_mfma_f32_16x16x32_bf16 v[92:95], v[172:175], v[132:135], v[92:95]
    v_mfma_f32_16x16x32_bf16 v[108:111], v[172:175], v[136:139], v[108:111]
    v_mfma_f32_16x16x32_bf16 v[124:127], v[172:175], v[140:143], v[124:127]
    s_waitcnt lgkmcnt(0)
    v_mfma_f32_16x16x32_bf16 v[64:67], v[176:179], v[144:147], v[64:67]
    v_mfma_f32_16x16x32_bf16 v[80:83], v[176:179], v[148:151], v[80:83]
    v_mfma_f32_16x16x32_bf16 v[96:99], v[176:179], v[152:155], v[96:99]
    v_mfma_f32_16x16x32_bf16 v[112:115], v[176:179], v[156:159], v[112:115]
    v_mfma_f32_16x16x32_bf16 v[68:71], v[180:183], v[144:147], v[68:71]
    v_mfma_f32_16x16x32_bf16 v[84:87], v[180:183], v[148:151], v[84:87]
    v_mfma_f32_16x16x32_bf16 v[100:103], v[180:183], v[152:155], v[100:103]
    v_mfma_f32_16x16x32_bf16 v[116:119], v[180:183], v[156:159], v[116:119]
    v_mfma_f32_16x16x32_bf16 v[72:75], v[184:187], v[144:147], v[72:75]
    v_mfma_f32_16x16x32_bf16 v[88:91], v[184:187], v[148:151], v[88:91]
    v_mfma_f32_16x16x32_bf16 v[104:107], v[184:187], v[152:155], v[104:107]
    v_mfma_f32_16x16x32_bf16 v[120:123], v[184:187], v[156:159], v[120:123]
    v_mfma_f32_16x16x32_bf16 v[76:79], v[188:191], v[144:147], v[76:79]
    v_mfma_f32_16x16x32_bf16 v[92:95], v[188:191], v[148:151], v[92:95]
    v_mfma_f32_16x16x32_bf16 v[108:111], v[188:191], v[152:155], v[108:111]
    v_mfma_f32_16x16x32_bf16 v[124:127], v[188:191], v[156:159], v[124:127]
    s_nop 7
    s_nop 7
    s_cmp_eq_u32 s27, 13
    s_cbranch_scc0 .Lk1_store_all
    s_cmp_eq_u32 s45, 0
    s_cbranch_scc1 .Lk1_end
.Lk1_store_all:
    v_lshlrev_b32 v30, 6, v2
    v_lshl_add_u32 v30, v3, 4, v30
    v_max_f32 v64, 0, v64
    v_max_f32 v65, 0, v65
    v_max_f32 v66, 0, v66
    v_max_f32 v67, 0, v67
    v_pk_mul_f32 v[64:65], v[64:65], v[64:65]
    v_pk_mul_f32 v[66:67], v[66:67], v[66:67]
    v_cvt_pk_bf16_f32 v64, v64, v65
    v_cvt_pk_bf16_f32 v65, v66, v67
    v_max_f32 v68, 0, v68
    v_max_f32 v69, 0, v69
    v_max_f32 v70, 0, v70
    v_max_f32 v71, 0, v71
    v_pk_mul_f32 v[68:69], v[68:69], v[68:69]
    v_pk_mul_f32 v[70:71], v[70:71], v[70:71]
    v_cvt_pk_bf16_f32 v66, v68, v69
    v_cvt_pk_bf16_f32 v67, v70, v71
    s_nop 1
    v_permlane32_swap_b32 v64, v66
    v_permlane32_swap_b32 v65, v67
    s_nop 1
    v_permlane16_swap_b32 v64, v66
    v_permlane16_swap_b32 v65, v67
    buffer_store_dwordx4 v[64:67], v30, s[16:19], s40 offen offset:0
    v_max_f32 v72, 0, v72
    v_max_f32 v73, 0, v73
    v_max_f32 v74, 0, v74
    v_max_f32 v75, 0, v75
    v_pk_mul_f32 v[72:73], v[72:73], v[72:73]
    v_pk_mul_f32 v[74:75], v[74:75], v[74:75]
    v_cvt_pk_bf16_f32 v72, v72, v73
    v_cvt_pk_bf16_f32 v73, v74, v75
    v_max_f32 v76, 0, v76
    v_max_f32 v77, 0, v77
    v_max_f32 v78, 0, v78
    v_max_f32 v79, 0, v79
    v_pk_mul_f32 v[76:77], v[76:77], v[76:77]
    v_pk_mul_f32 v[78:79], v[78:79], v[78:79]
    v_cvt_pk_bf16_f32 v74, v76, v77
    v_cvt_pk_bf16_f32 v75, v78, v79
    s_nop 1
    v_permlane32_swap_b32 v72, v74
    v_permlane32_swap_b32 v73, v75
    s_nop 1
    v_permlane16_swap_b32 v72, v74
    v_permlane16_swap_b32 v73, v75
    buffer_store_dwordx4 v[72:75], v30, s[16:19], s40 offen offset:1024
    v_max_f32 v80, 0, v80
    v_max_f32 v81, 0, v81
    v_max_f32 v82, 0, v82
    v_max_f32 v83, 0, v83
    v_pk_mul_f32 v[80:81], v[80:81], v[80:81]
    v_pk_mul_f32 v[82:83], v[82:83], v[82:83]
    v_cvt_pk_bf16_f32 v80, v80, v81
    v_cvt_pk_bf16_f32 v81, v82, v83
    v_max_f32 v84, 0, v84
    v_max_f32 v85, 0, v85
    v_max_f32 v86, 0, v86
    v_max_f32 v87, 0, v87
    v_pk_mul_f32 v[84:85], v[84:85], v[84:85]
    v_pk_mul_f32 v[86:87], v[86:87], v[86:87]
    v_cvt_pk_bf16_f32 v82, v84, v85
    v_cvt_pk_bf16_f32 v83, v86, v87
    s_nop 1
    v_permlane32_swap_b32 v80, v82
    v_permlane32_swap_b32 v81, v83
    s_nop 1
    v_permlane16_swap_b32 v80, v82
    v_permlane16_swap_b32 v81, v83
    buffer_store_dwordx4 v[80:83], v30, s[16:19], s41 offen offset:0
    v_max_f32 v88, 0, v88
    v_max_f32 v89, 0, v89
    v_max_f32 v90, 0, v90
    v_max_f32 v91, 0, v91
    v_pk_mul_f32 v[88:89], v[88:89], v[88:89]
    v_pk_mul_f32 v[90:91], v[90:91], v[90:91]
    v_cvt_pk_bf16_f32 v88, v88, v89
    v_cvt_pk_bf16_f32 v89, v90, v91
    v_max_f32 v92, 0, v92
    v_max_f32 v93, 0, v93
    v_max_f32 v94, 0, v94
    v_max_f32 v95, 0, v95
    v_pk_mul_f32 v[92:93], v[92:93], v[92:93]
    v_pk_mul_f32 v[94:95], v[94:95], v[94:95]
    v_cvt_pk_bf16_f32 v90, v92, v93
    v_cvt_pk_bf16_f32 v91, v94, v95
    s_nop 1
    v_permlane32_swap_b32 v88, v90
    v_permlane32_swap_b32 v89, v91
    s_nop 1
    v_permlane16_swap_b32 v88, v90
    v_permlane16_swap_b32 v89, v91
    buffer_store_dwordx4 v[88:91], v30, s[16:19], s41 offen offset:1024
    v_max_f32 v96, 0, v96
    v_max_f32 v97, 0, v97
    v_max_f32 v98, 0, v98
    v_max_f32 v99, 0, v99
    v_pk_mul_f32 v[96:97], v[96:97], v[96:97]
    v_pk_mul_f32 v[98:99], v[98:99], v[98:99]
    v_cvt_pk_bf16_f32 v96, v96, v97
    v_cvt_pk_bf16_f32 v97, v98, v99
    v_max_f32 v100, 0, v100
    v_max_f32 v101, 0, v101
    v_max_f32 v102, 0, v102
    v_max_f32 v103, 0, v103
    v_pk_mul_f32 v[100:101], v[100:101], v[100:101]
    v_pk_mul_f32 v[102:103], v[102:103], v[102:103]
    v_cvt_pk_bf16_f32 v98, v100, v101
    v_cvt_pk_bf16_f32 v99, v102, v103
    s_nop 1
    v_permlane32_swap_b32 v96, v98
    v_permlane32_swap_b32 v97, v99
    s_nop 1
    v_permlane16_swap_b32 v96, v98
    v_permlane16_swap_b32 v97, v99
    buffer_store_dwordx4 v[96:99], v30, s[16:19], s42 offen offset:0
    v_max_f32 v104, 0, v104
    v_max_f32 v105, 0, v105
    v_max_f32 v106, 0, v106
    v_max_f32 v107, 0, v107
    v_pk_mul_f32 v[104:105], v[104:105], v[104:105]
    v_pk_mul_f32 v[106:107], v[106:107], v[106:107]
    v_cvt_pk_bf16_f32 v104, v104, v105
    v_cvt_pk_bf16_f32 v105, v106, v107
    v_max_f32 v108, 0, v108
    v_max_f32 v109, 0, v109
    v_max_f32 v110, 0, v110
    v_max_f32 v111, 0, v111
    v_pk_mul_f32 v[108:109], v[108:109], v[108:109]
    v_pk_mul_f32 v[110:111], v[110:111], v[110:111]
    v_cvt_pk_bf16_f32 v106, v108, v109
    v_cvt_pk_bf16_f32 v107, v110, v111
    s_nop 1
    v_permlane32_swap_b32 v104, v106
    v_permlane32_swap_b32 v105, v107
    s_nop 1
    v_permlane16_swap_b32 v104, v106
    v_permlane16_swap_b32 v105, v107
    buffer_store_dwordx4 v[104:107], v30, s[16:19], s42 offen offset:1024
    v_max_f32 v112, 0, v112
    v_max_f32 v113, 0, v113
    v_max_f32 v114, 0, v114
    v_max_f32 v115, 0, v115
    v_pk_mul_f32 v[112:113], v[112:113], v[112:113]
    v_pk_mul_f32 v[114:115], v[114:115], v[114:115]
    v_cvt_pk_bf16_f32 v112, v112, v113
    v_cvt_pk_bf16_f32 v113, v114, v115
    v_max_f32 v116, 0, v116
    v_max_f32 v117, 0, v117
    v_max_f32 v118, 0, v118
    v_max_f32 v119, 0, v119
    v_pk_mul_f32 v[116:117], v[116:117], v[116:117]
    v_pk_mul_f32 v[118:119], v[118:119], v[118:119]
    v_cvt_pk_bf16_f32 v114, v116, v117
    v_cvt_pk_bf16_f32 v115, v118, v119
    s_nop 1
    v_permlane32_swap_b32 v112, v114
    v_permlane32_swap_b32 v113, v115
    s_nop 1
    v_permlane16_swap_b32 v112, v114
    v_permlane16_swap_b32 v113, v115
    buffer_store_dwordx4 v[112:115], v30, s[16:19], s43 offen offset:0
    v_max_f32 v120, 0, v120
    v_max_f32 v121, 0, v121
    v_max_f32 v122, 0, v122
    v_max_f32 v123, 0, v123
    v_pk_mul_f32 v[120:121], v[120:121], v[120:121]
    v_pk_mul_f32 v[122:123], v[122:123], v[122:123]
    v_cvt_pk_bf16_f32 v120, v120, v121
    v_cvt_pk_bf16_f32 v121, v122, v123
    v_max_f32 v124, 0, v124
    v_max_f32 v125, 0, v125
    v_max_f32 v126, 0, v126
    v_max_f32 v127, 0, v127
    v_pk_mul_f32 v[124:125], v[124:125], v[124:125]
    v_pk_mul_f32 v[126:127], v[126:127], v[126:127]
    v_cvt_pk_bf16_f32 v122, v124, v125
    v_cvt_pk_bf16_f32 v123, v126, v127
    s_nop 1
    v_permlane32_swap_b32 v120, v122
    v_permlane32_swap_b32 v121, v123
    s_nop 1
    v_permlane16_swap_b32 v120, v122
    v_permlane16_swap_b32 v121, v123
    buffer_store_dwordx4 v[120:123], v30, s[16:19], s43 offen offset:1024
    s_branch .Lk1_end
.Lk1_producer:
    s_sub_u32 s44, s28, 4
    v_lshrrev_b32 v4, 3, v1
    v_and_b32 v5, 7, v1
    v_xor_b32 v5, v5, v4
    v_lshlrev_b32 v5, 4, v5
    v_mul_u32_u24 v12, 1280, v4
    v_add_u32 v12, v12, v5
    v_add_u32 v4, 0, v3
    v_lshrrev_b32 v5, 1, v2
    v_xor_b32 v5, v5, v4
    v_lshlrev_b32 v5, 1, v5
    v_and_b32 v6, 1, v2
    v_or_b32 v5, v5, v6
    v_lshlrev_b32 v5, 4, v5
    v_mul_u32_u24 v13, 3456, v3
    v_add_u32 v13, v13, v5
    v_add_u32 v4, 4, v3
    v_lshrrev_b32 v5, 1, v2
    v_xor_b32 v5, v5, v4
    v_lshlrev_b32 v5, 1, v5
    v_and_b32 v6, 1, v2
    v_or_b32 v5, v5, v6
    v_lshlrev_b32 v5, 4, v5
    v_mul_u32_u24 v14, 3456, v3
    v_add_u32 v14, v14, v5
    s_mul_i32 s33, s26, 163840
    s_mul_i32 s29, s44, 40960
    s_add_u32 s33, s33, s29
    s_lshl_b32 s35, s44, 12
    s_add_u32 s36, s35, 16384
    s_mul_i32 s34, s44, 55296
    s_add_u32 s34, s34, s31
    s_add_u32 m0, s35, 0
    s_add_u32 s37, s33, 0
    buffer_load_dwordx4 v12, s[4:7], s37 offen lds
    s_add_u32 m0, s35, 1024
    s_add_u32 s37, s33, 10240
    buffer_load_dwordx4 v12, s[4:7], s37 offen lds
    s_add_u32 m0, s35, 2048
    s_add_u32 s37, s33, 20480
    buffer_load_dwordx4 v12, s[4:7], s37 offen lds
    s_add_u32 m0, s35, 3072
    s_add_u32 s37, s33, 30720
    buffer_load_dwordx4 v12, s[4:7], s37 offen lds
    s_add_u32 m0, s36, 0
    s_add_u32 s37, s34, 0
    buffer_load_dwordx4 v13, s[8:11], s37 offen lds
    s_add_u32 m0, s36, 1024
    s_add_u32 s37, s34, 27648
    buffer_load_dwordx4 v14, s[8:11], s37 offen lds
    s_add_u32 m0, s36, 2048
    s_add_u32 s37, s34, 13824
    buffer_load_dwordx4 v13, s[8:11], s37 offen lds
    s_add_u32 m0, s36, 3072
    s_add_u32 s37, s34, 41472
    buffer_load_dwordx4 v14, s[8:11], s37 offen lds
    s_add_u32 m0, s35, 32768
    s_add_u32 s37, s33, 128
    buffer_load_dwordx4 v12, s[4:7], s37 offen lds
    s_add_u32 m0, s35, 33792
    s_add_u32 s37, s33, 10368
    buffer_load_dwordx4 v12, s[4:7], s37 offen lds
    s_add_u32 m0, s35, 34816
    s_add_u32 s37, s33, 20608
    buffer_load_dwordx4 v12, s[4:7], s37 offen lds
    s_add_u32 m0, s35, 35840
    s_add_u32 s37, s33, 30848
    buffer_load_dwordx4 v12, s[4:7], s37 offen lds
    s_add_u32 m0, s36, 32768
    s_add_u32 s37, s34, 221184
    buffer_load_dwordx4 v13, s[8:11], s37 offen lds
    s_add_u32 m0, s36, 33792
    s_add_u32 s37, s34, 248832
    buffer_load_dwordx4 v14, s[8:11], s37 offen lds
    s_add_u32 m0, s36, 34816
    s_add_u32 s37, s34, 235008
    buffer_load_dwordx4 v13, s[8:11], s37 offen lds
    s_add_u32 m0, s36, 35840
    s_add_u32 s37, s34, 262656
    buffer_load_dwordx4 v14, s[8:11], s37 offen lds
    s_waitcnt vmcnt(8)
    s_barrier
    s_add_u32 m0, s35, 65536
    s_add_u32 s37, s33, 256
    buffer_load_dwordx4 v12, s[4:7], s37 offen lds
    s_add_u32 m0, s35, 66560
    s_add_u32 s37, s33, 10496
    buffer_load_dwordx4 v12, s[4:7], s37 offen lds
    s_add_u32 m0, s35, 67584
    s_add_u32 s37, s33, 20736
    buffer_load_dwordx4 v12, s[4:7], s37 offen lds
    s_add_u32 m0, s35, 68608
    s_add_u32 s37, s33, 30976
    buffer_load_dwordx4 v12, s[4:7], s37 offen lds
    s_add_u32 m0, s36, 65536
    s_add_u32 s37, s34, 442368
    buffer_load_dwordx4 v13, s[8:11], s37 offen lds
    s_add_u32 m0, s36, 66560
    s_add_u32 s37, s34, 470016
    buffer_load_dwordx4 v14, s[8:11], s37 offen lds
    s_add_u32 m0, s36, 67584
    s_add_u32 s37, s34, 456192
    buffer_load_dwordx4 v13, s[8:11], s37 offen lds
    s_add_u32 m0, s36, 68608
    s_add_u32 s37, s34, 483840
    buffer_load_dwordx4 v14, s[8:11], s37 offen lds
    s_add_u32 m0, s35, 98304
    s_add_u32 s37, s33, 384
    buffer_load_dwordx4 v12, s[4:7], s37 offen lds
    s_add_u32 m0, s35, 99328
    s_add_u32 s37, s33, 10624
    buffer_load_dwordx4 v12, s[4:7], s37 offen lds
    s_add_u32 m0, s35, 100352
    s_add_u32 s37, s33, 20864
    buffer_load_dwordx4 v12, s[4:7], s37 offen lds
    s_add_u32 m0, s35, 101376
    s_add_u32 s37, s33, 31104
    buffer_load_dwordx4 v12, s[4:7], s37 offen lds
    s_add_u32 m0, s36, 98304
    s_add_u32 s37, s34, 663552
    buffer_load_dwordx4 v13, s[8:11], s37 offen lds
    s_add_u32 m0, s36, 99328
    s_add_u32 s37, s34, 691200
    buffer_load_dwordx4 v14, s[8:11], s37 offen lds
    s_add_u32 m0, s36, 100352
    s_add_u32 s37, s34, 677376
    buffer_load_dwordx4 v13, s[8:11], s37 offen lds
    s_add_u32 m0, s36, 101376
    s_add_u32 s37, s34, 705024
    buffer_load_dwordx4 v14, s[8:11], s37 offen lds
    s_waitcnt vmcnt(16)
    s_barrier
    s_add_u32 m0, s35, 0
    s_add_u32 s37, s33, 512
    buffer_load_dwordx4 v12, s[4:7], s37 offen lds
    s_add_u32 m0, s35, 1024
    s_add_u32 s37, s33, 10752
    buffer_load_dwordx4 v12, s[4:7], s37 offen lds
    s_add_u32 m0, s35, 2048
    s_add_u32 s37, s33, 20992
    buffer_load_dwordx4 v12, s[4:7], s37 offen lds
    s_add_u32 m0, s35, 3072
    s_add_u32 s37, s33, 31232
    buffer_load_dwordx4 v12, s[4:7], s37 offen lds
    s_add_u32 m0, s36, 0
    s_add_u32 s37, s34, 884736
    buffer_load_dwordx4 v13, s[8:11], s37 offen lds
    s_add_u32 m0, s36, 1024
    s_add_u32 s37, s34, 912384
    buffer_load_dwordx4 v14, s[8:11], s37 offen lds
    s_add_u32 m0, s36, 2048
    s_add_u32 s37, s34, 898560
    buffer_load_dwordx4 v13, s[8:11], s37 offen lds
    s_add_u32 m0, s36, 3072
    s_add_u32 s37, s34, 926208
    buffer_load_dwordx4 v14, s[8:11], s37 offen lds
    s_waitcnt vmcnt(16)
    s_barrier
    s_add_u32 m0, s35, 32768
    s_add_u32 s37, s33, 640
    buffer_load_dwordx4 v12, s[4:7], s37 offen lds
    s_add_u32 m0, s35, 33792
    s_add_u32 s37, s33, 10880
    buffer_load_dwordx4 v12, s[4:7], s37 offen lds
    s_add_u32 m0, s35, 34816
    s_add_u32 s37, s33, 21120
    buffer_load_dwordx4 v12, s[4:7], s37 offen lds
    s_add_u32 m0, s35, 35840
    s_add_u32 s37, s33, 31360
    buffer_load_dwordx4 v12, s[4:7], s37 offen lds
    s_add_u32 m0, s36, 32768
    s_add_u32 s37, s34, 1105920
    buffer_load_dwordx4 v13, s[8:11], s37 offen lds
    s_add_u32 m0, s36, 33792
    s_add_u32 s37, s34, 1133568
    buffer_load_dwordx4 v14, s[8:11], s37 offen lds
    s_add_u32 m0, s36, 34816
    s_add_u32 s37, s34, 1119744
    buffer_load_dwordx4 v13, s[8:11], s37 offen lds
    s_add_u32 m0, s36, 35840
    s_add_u32 s37, s34, 1147392
    buffer_load_dwordx4 v14, s[8:11], s37 offen lds
    s_waitcnt vmcnt(16)
    s_barrier
    s_add_u32 m0, s35, 65536
    s_add_u32 s37, s33, 768
    buffer_load_dwordx4 v12, s[4:7], s37 offen lds
    s_add_u32 m0, s35, 66560
    s_add_u32 s37, s33, 11008
    buffer_load_dwordx4 v12, s[4:7], s37 offen lds
    s_add_u32 m0, s35, 67584
    s_add_u32 s37, s33, 21248
    buffer_load_dwordx4 v12, s[4:7], s37 offen lds
    s_add_u32 m0, s35, 68608
    s_add_u32 s37, s33, 31488
    buffer_load_dwordx4 v12, s[4:7], s37 offen lds
    s_add_u32 m0, s36, 65536
    s_add_u32 s37, s34, 1327104
    buffer_load_dwordx4 v13, s[8:11], s37 offen lds
    s_add_u32 m0, s36, 66560
    s_add_u32 s37, s34, 1354752
    buffer_load_dwordx4 v14, s[8:11], s37 offen lds
    s_add_u32 m0, s36, 67584
    s_add_u32 s37, s34, 1340928
    buffer_load_dwordx4 v13, s[8:11], s37 offen lds
    s_add_u32 m0, s36, 68608
    s_add_u32 s37, s34, 1368576
    buffer_load_dwordx4 v14, s[8:11], s37 offen lds
    s_waitcnt vmcnt(16)
    s_barrier
    s_add_u32 m0, s35, 98304
    s_add_u32 s37, s33, 896
    buffer_load_dwordx4 v12, s[4:7], s37 offen lds
    s_add_u32 m0, s35, 99328
    s_add_u32 s37, s33, 11136
    buffer_load_dwordx4 v12, s[4:7], s37 offen lds
    s_add_u32 m0, s35, 100352
    s_add_u32 s37, s33, 21376
    buffer_load_dwordx4 v12, s[4:7], s37 offen lds
    s_add_u32 m0, s35, 101376
    s_add_u32 s37, s33, 31616
    buffer_load_dwordx4 v12, s[4:7], s37 offen lds
    s_add_u32 m0, s36, 98304
    s_add_u32 s37, s34, 1548288
    buffer_load_dwordx4 v13, s[8:11], s37 offen lds
    s_add_u32 m0, s36, 99328
    s_add_u32 s37, s34, 1575936
    buffer_load_dwordx4 v14, s[8:11], s37 offen lds
    s_add_u32 m0, s36, 100352
    s_add_u32 s37, s34, 1562112
    buffer_load_dwordx4 v13, s[8:11], s37 offen lds
    s_add_u32 m0, s36, 101376
    s_add_u32 s37, s34, 1589760
    buffer_load_dwordx4 v14, s[8:11], s37 offen lds
    s_waitcnt vmcnt(16)
    s_barrier
    s_add_u32 m0, s35, 0
    s_add_u32 s37, s33, 1024
    buffer_load_dwordx4 v12, s[4:7], s37 offen lds
    s_add_u32 m0, s35, 1024
    s_add_u32 s37, s33, 11264
    buffer_load_dwordx4 v12, s[4:7], s37 offen lds
    s_add_u32 m0, s35, 2048
    s_add_u32 s37, s33, 21504
    buffer_load_dwordx4 v12, s[4:7], s37 offen lds
    s_add_u32 m0, s35, 3072
    s_add_u32 s37, s33, 31744
    buffer_load_dwordx4 v12, s[4:7], s37 offen lds
    s_add_u32 m0, s36, 0
    s_add_u32 s37, s34, 1769472
    buffer_load_dwordx4 v13, s[8:11], s37 offen lds
    s_add_u32 m0, s36, 1024
    s_add_u32 s37, s34, 1797120
    buffer_load_dwordx4 v14, s[8:11], s37 offen lds
    s_add_u32 m0, s36, 2048
    s_add_u32 s37, s34, 1783296
    buffer_load_dwordx4 v13, s[8:11], s37 offen lds
    s_add_u32 m0, s36, 3072
    s_add_u32 s37, s34, 1810944
    buffer_load_dwordx4 v14, s[8:11], s37 offen lds
    s_waitcnt vmcnt(16)
    s_barrier
    s_add_u32 m0, s35, 32768
    s_add_u32 s37, s33, 1152
    buffer_load_dwordx4 v12, s[4:7], s37 offen lds
    s_add_u32 m0, s35, 33792
    s_add_u32 s37, s33, 11392
    buffer_load_dwordx4 v12, s[4:7], s37 offen lds
    s_add_u32 m0, s35, 34816
    s_add_u32 s37, s33, 21632
    buffer_load_dwordx4 v12, s[4:7], s37 offen lds
    s_add_u32 m0, s35, 35840
    s_add_u32 s37, s33, 31872
    buffer_load_dwordx4 v12, s[4:7], s37 offen lds
    s_add_u32 m0, s36, 32768
    s_add_u32 s37, s34, 1990656
    buffer_load_dwordx4 v13, s[8:11], s37 offen lds
    s_add_u32 m0, s36, 33792
    s_add_u32 s37, s34, 2018304
    buffer_load_dwordx4 v14, s[8:11], s37 offen lds
    s_add_u32 m0, s36, 34816
    s_add_u32 s37, s34, 2004480
    buffer_load_dwordx4 v13, s[8:11], s37 offen lds
    s_add_u32 m0, s36, 35840
    s_add_u32 s37, s34, 2032128
    buffer_load_dwordx4 v14, s[8:11], s37 offen lds
    s_waitcnt vmcnt(16)
    s_barrier
    s_waitcnt vmcnt(8)
    s_barrier
    s_waitcnt vmcnt(0)
    s_barrier
    s_branch .Lk1_end
.Lk1_retile:
    s_sub_u32 s44, s25, 28
    s_lshl_b32 s44, s44, 3
    s_add_u32 s44, s44, s24
    s_mul_i32 s29, s28, 320
    s_add_u32 s29, s29, 0
    v_add_u32 v4, s29, v1
    v_mul_u32_u24 v5, 13108, v4
    v_lshrrev_b32 v5, 20, v5
    v_mul_u32_u24 v6, 80, v5
    v_sub_u32 v6, v4, v6
    v_lshrrev_b32 v7, 1, v6
    v_xor_b32 v8, v7, v5
    v_and_b32 v8, 7, v8
    v_and_b32 v7, 0xfffffff8, v7
    v_or_b32 v7, v7, v8
    v_and_b32 v6, 1, v6
    v_lshl_add_u32 v7, v7, 1, v6
    v_and_b32 v8, 4, v5
    v_lshlrev_b32 v8, 1, v8
    v_and_b32 v9, 8, v5
    v_lshrrev_b32 v9, 1, v9
    v_and_b32 v6, 0xfffffff3, v5
    v_or3_b32 v6, v6, v8, v9
    v_mul_u32_u24 v12, 1280, v6
    v_lshl_add_u32 v12, v7, 4, v12
    s_mul_i32 s29, s28, 320
    s_add_u32 s29, s29, 64
    v_add_u32 v4, s29, v1
    v_mul_u32_u24 v5, 13108, v4
    v_lshrrev_b32 v5, 20, v5
    v_mul_u32_u24 v6, 80, v5
    v_sub_u32 v6, v4, v6
    v_lshrrev_b32 v7, 1, v6
    v_xor_b32 v8, v7, v5
    v_and_b32 v8, 7, v8
    v_and_b32 v7, 0xfffffff8, v7
    v_or_b32 v7, v7, v8
    v_and_b32 v6, 1, v6
    v_lshl_add_u32 v7, v7, 1, v6
    v_and_b32 v8, 4, v5
    v_lshlrev_b32 v8, 1, v8
    v_and_b32 v9, 8, v5
    v_lshrrev_b32 v9, 1, v9
    v_and_b32 v6, 0xfffffff3, v5
    v_or3_b32 v6, v6, v8, v9
    v_mul_u32_u24 v13, 1280, v6
    v_lshl_add_u32 v13, v7, 4, v13
    s_mul_i32 s29, s28, 320
    s_add_u32 s29, s29, 128
    v_add_u32 v4, s29, v1
    v_mul_u32_u24 v5, 13108, v4
    v_lshrrev_b32 v5, 20, v5
    v_mul_u32_u24 v6, 80, v5
    v_sub_u32 v6, v4, v6
    v_lshrrev_b32 v7, 1, v6
    v_xor_b32 v8, v7, v5
    v_and_b32 v8, 7, v8
    v_and_b32 v7, 0xfffffff8, v7
    v_or_b32 v7, v7, v8
    v_and_b32 v6, 1, v6
    v_lshl_add_u32 v7, v7, 1, v6
    v_and_b32 v8, 4, v5
    v_lshlrev_b32 v8, 1, v8
    v_and_b32 v9, 8, v5
    v_lshrrev_b32 v9, 1, v9
    v_and_b32 v6, 0xfffffff3, v5
    v_or3_b32 v6, v6, v8, v9
    v_mul_u32_u24 v14, 1280, v6
    v_lshl_add_u32 v14, v7, 4, v14
    s_mul_i32 s29, s28, 320
    s_add_u32 s29, s29, 192
    v_add_u32 v4, s29, v1
    v_mul_u32_u24 v5, 13108, v4
    v_lshrrev_b32 v5, 20, v5
    v_mul_u32_u24 v6, 80, v5
    v_sub_u32 v6, v4, v6
    v_lshrrev_b32 v7, 1, v6
    v_xor_b32 v8, v7, v5
    v_and_b32 v8, 7, v8
    v_and_b32 v7, 0xfffffff8, v7
    v_or_b32 v7, v7, v8
    v_and_b32 v6, 1, v6
    v_lshl_add_u32 v7, v7, 1, v6
    v_and_b32 v8, 4, v5
    v_lshlrev_b32 v8, 1, v8
    v_and_b32 v9, 8, v5
    v_lshrrev_b32 v9, 1, v9
    v_and_b32 v6, 0xfffffff3, v5
    v_or3_b32 v6, v6, v8, v9
    v_mul_u32_u24 v15, 1280, v6
    v_lshl_add_u32 v15, v7, 4, v15
    s_mul_i32 s29, s28, 320
    s_add_u32 s29, s29, 256
    v_add_u32 v4, s29, v1
    v_mul_u32_u24 v5, 13108, v4
    v_lshrrev_b32 v5, 20, v5
    v_mul_u32_u24 v6, 80, v5
    v_sub_u32 v6, v4, v6
    v_lshrrev_b32 v7, 1, v6
    v_xor_b32 v8, v7, v5
    v_and_b32 v8, 7, v8
    v_and_b32 v7, 0xfffffff8, v7
    v_or_b32 v7, v7, v8
    v_and_b32 v6, 1, v6
    v_lshl_add_u32 v7, v7, 1, v6
    v_and_b32 v8, 4, v5
    v_lshlrev_b32 v8, 1, v8
    v_and_b32 v9, 8, v5
    v_lshrrev_b32 v9, 1, v9
    v_and_b32 v6, 0xfffffff3, v5
    v_or3_b32 v6, v6, v8, v9
    v_mul_u32_u24 v16, 1280, v6
    v_lshl_add_u32 v16, v7, 4, v16
    v_and_b32 v4, 1, v3
    v_lshlrev_b32 v4, 2, v4
    v_lshrrev_b32 v5, 2, v2
    v_add_u32 v4, v4, v5
    v_lshrrev_b32 v5, 1, v3
    v_lshl_add_u32 v5, v5, 4, v4
    v_mul_u32_u24 v5, 1280, v5
    v_and_b32 v6, 3, v2
    v_lshl_add_u32 v5, v6, 3, v5
    s_mul_i32 s30, s28, 5
    v_mov_b32 v6, 0
    v_add_u32 v6, s30, v6
    v_xor_b32 v7, v6, v4
    v_and_b32 v7, 7, v7
    v_and_b32 v6, 0xfffffff8, v6
    v_or_b32 v6, v6, v7
    v_lshl_add_u32 v20, v6, 5, v5
    v_mov_b32 v6, 1
    v_add_u32 v6, s30, v6
    v_xor_b32 v7, v6, v4
    v_and_b32 v7, 7, v7
    v_and_b32 v6, 0xfffffff8, v6
    v_or_b32 v6, v6, v7
    v_lshl_add_u32 v21, v6, 5, v5
    v_mov_b32 v6, 2
    v_add_u32 v6, s30, v6
    v_xor_b32 v7, v6, v4
    v_and_b32 v7, 7, v7
    v_and_b32 v6, 0xfffffff8, v6
    v_or_b32 v6, v6, v7
    v_lshl_add_u32 v22, v6, 5, v5
    v_mov_b32 v6, 3
    v_add_u32 v6, s30, v6
    v_xor_b32 v7, v6, v4
    v_and_b32 v7, 7, v7
    v_and_b32 v6, 0xfffffff8, v6
    v_or_b32 v6, v6, v7
    v_lshl_add_u32 v23, v6, 5, v5
    v_mov_b32 v6, 4
    v_add_u32 v6, s30, v6
    v_xor_b32 v7, v6, v4
    v_and_b32 v7, 7, v7
    v_and_b32 v6, 0xfffffff8, v6
    v_or_b32 v6, v6, v7
    v_lshl_add_u32 v24, v6, 5, v5
    v_lshlrev_b32 v26, 4, v1
    s_mul_i32 s35, s28, 5120
    s_mov_b32 s45, s44
.Lk1_rt_loop:
    s_mul_i32 s37, s45, 40960
    s_add_u32 m0, s35, 0
    s_nop 0
    buffer_load_dwordx4 v12, s[20:23], s37 offen lds
    s_add_u32 m0, s35, 1024
    s_nop 0
    buffer_load_dwordx4 v13, s[20:23], s37 offen lds
    s_add_u32 m0, s35, 2048
    s_nop 0
    buffer_load_dwordx4 v14, s[20:23], s37 offen lds
    s_add_u32 m0, s35, 3072
    s_nop 0
    buffer_load_dwordx4 v15, s[20:23], s37 offen lds
    s_add_u32 m0, s35, 4096
    s_nop 0
    buffer_load_dwordx4 v16, s[20:23], s37 offen lds
    s_waitcnt vmcnt(0)
    s_barrier
    ds_read_b64_tr_b16 v[32:33], v20 offset:0
    ds_read_b64_tr_b16 v[34:35], v20 offset:10240
    ds_read_b64_tr_b16 v[36:37], v21 offset:0
    ds_read_b64_tr_b16 v[38:39], v21 offset:10240
    ds_read_b64_tr_b16 v[40:41], v22 offset:0
    ds_read_b64_tr_b16 v[42:43], v22 offset:10240
    ds_read_b64_tr_b16 v[44:45], v23 offset:0
    ds_read_b64_tr_b16 v[46:47], v23 offset:10240
    ds_read_b64_tr_b16 v[48:49], v24 offset:0
    ds_read_b64_tr_b16 v[50:51], v24 offset:10240
    s_waitcnt lgkmcnt(0)
    s_barrier
    s_mul_i32 s29, s45, 40
    s_add_u32 s29, s29, s30
    s_lshl_b32 s29, s29, 10
    s_add_u32 s29, s29, 8388608
    buffer_store_dwordx4 v[32:35], v26, s[16:19], s29 offen offset:0
    buffer_store_dwordx4 v[36:39], v26, s[16:19], s29 offen offset:1024
    buffer_store_dwordx4 v[40:43], v26, s[16:19], s29 offen offset:2048
    buffer_store_dwordx4 v[44:47], v26, s[16:19], s29 offen offset:3072
    s_add_u32 s29, s29, 4096
    buffer_store_dwordx4 v[48:51], v26, s[16:19], s29 offen offset:0
    s_add_u32 s45, s45, 32
    s_cmp_lt_u32 s45, 54
    s_cbranch_scc1 .Lk1_rt_loop
.Lk1_end:
    s_endpgm
.globl mlp_gemm2_kernel
.p2align 8
.type mlp_gemm2_kernel,@function
mlp_gemm2_kernel:
    s_cmp_ge_u32 s2, 256
    s_cbranch_scc1 .Lk2_end
    s_load_dwordx2 s[4:5], s[0:1], 56
    s_load_dwordx2 s[12:13], s[0:1], 32
    s_load_dwordx2 s[16:17], s[0:1], 40
    s_and_b32 s24, s2, 7
    s_lshr_b32 s25, s2, 3
    s_lshr_b32 s26, s24, 1
    s_lshl_b32 s26, s26, 3
    s_lshr_b32 s29, s25, 2
    s_add_u32 s26, s26, s29
    s_and_b32 s27, s24, 1
    s_lshl_b32 s27, s27, 2
    s_and_b32 s29, s25, 3
    s_add_u32 s27, s27, s29
    s_mul_i32 s31, s27, 160
    v_lshrrev_b32 v4, 6, v0
    v_and_b32 v1, 63, v0
    s_nop 0
    v_readfirstlane_b32 s28, v4
    v_and_b32 v2, 15, v1
    v_lshrrev_b32 v3, 4, v1
    v_lshlrev_b32 v12, 4, v1
    s_waitcnt lgkmcnt(0)
    s_mov_b32 s6, 10600448
    s_mov_b32 s7, 0x00020000
    s_mov_b32 s14, 1280
    s_mov_b32 s15, 0x00020000
    s_mov_b32 s18, 2621440
    s_mov_b32 s19, 0x00020000
    s_and_b32 s30, s28, 3
    s_cmp_ge_u32 s28, 4
    s_cbranch_scc1 .Lk2_producer
    v_lshlrev_b32 v15, 3, v3
    v_add_u32 v15, s31, v15
    buffer_load_dwordx2 v[24:25], v15, s[12:15], 0 offen offset:0
    buffer_load_dwordx2 v[26:27], v15, s[12:15], 0 offen offset:32
    buffer_load_dwordx2 v[28:29], v15, s[12:15], 0 offen offset:64
    buffer_load_dwordx2 v[30:31], v15, s[12:15], 0 offen offset:96
    buffer_load_dwordx2 v[32:33], v15, s[12:15], 0 offen offset:128
    v_lshlrev_b32 v16, 6, v2
    v_lshl_add_u32 v16, v3, 4, v16
    s_lshl_b32 s36, s26, 2
    s_add_u32 s36, s36, s30
    s_mul_i32 s36, s36, 55296
    s_add_u32 s34, s36, 0
    buffer_load_dwordx4 v[136:139], v16, s[4:7], s34 offen
    s_add_u32 s34, s36, 1024
    buffer_load_dwordx4 v[140:143], v16, s[4:7], s34 offen
    s_add_u32 s34, s36, 2048
    buffer_load_dwordx4 v[144:147], v16, s[4:7], s34 offen
    s_add_u32 s34, s36, 3072
    buffer_load_dwordx4 v[148:151], v16, s[4:7], s34 offen
    s_add_u32 s34, s36, 4096
    buffer_load_dwordx4 v[152:155], v16, s[4:7], s34 offen
    s_add_u32 s34, s36, 5120
    buffer_load_dwordx4 v[156:159], v16, s[4:7], s34 offen
    s_add_u32 s34, s36, 6144
    buffer_load_dwordx4 v[160:163], v16, s[4:7], s34 offen
    s_add_u32 s34, s36, 7168
    buffer_load_dwordx4 v[164:167], v16, s[4:7], s34 offen
    s_add_u32 s34, s36, 8192
    buffer_load_dwordx4 v[168:171], v16, s[4:7], s34 offen
    s_add_u32 s34, s36, 9216
    buffer_load_dwordx4 v[172:175], v16, s[4:7], s34 offen
    s_add_u32 s34, s36, 10240
    buffer_load_dwordx4 v[176:179], v16, s[4:7], s34 offen
    s_add_u32 s34, s36, 11264
    buffer_load_dwordx4 v[180:183], v16, s[4:7], s34 offen
    v_mov_b32 v17, v12
    v_add_u32 v18, 20480, v17
    v_add_u32 v19, 40960, v17
    v_add_u32 v20, 61440, v17
    v_add_u32 v21, 81920, v17
    v_add_u32 v22, 102400, v17
    v_add_u32 v23, 122880, v17
    s_lshl_b32 s29, s26, 6
    s_lshl_b32 s34, s30, 4
    s_add_u32 s29, s29, s34
    v_add_u32 v14, s29, v2
    v_mul_u32_u24 v14, 1280, v14
    v_add_u32 v14, v15, v14
    s_waitcnt vmcnt(12)
    v_lshlrev_b32 v34, 16, v24
    v_and_b32 v35, 0xffff0000, v24
    v_lshlrev_b32 v36, 16, v25
    v_and_b32 v37, 0xffff0000, v25
    v_lshlrev_b32 v38, 16, v26
    v_and_b32 v39, 0xffff0000, v26
    v_lshlrev_b32 v40, 16, v27
    v_and_b32 v41, 0xffff0000, v27
    v_lshlrev_b32 v42, 16, v28
    v_and_b32 v43, 0xffff0000, v28
    v_lshlrev_b32 v44, 16, v29
    v_and_b32 v45, 0xffff0000, v29
    v_lshlrev_b32 v46, 16, v30
    v_and_b32 v47, 0xffff0000, v30
    v_lshlrev_b32 v48, 16, v31
    v_and_b32 v49, 0xffff0000, v31
    v_lshlrev_b32 v50, 16, v32
    v_and_b32 v51, 0xffff0000, v32
    v_lshlrev_b32 v52, 16, v33
    v_and_b32 v53, 0xffff0000, v33
    s_barrier
    ds_read_b128 v[76:79], v17 offset:0
    ds_read_b128 v[80:83], v17 offset:1024
    ds_read_b128 v[84:87], v17 offset:2048
    ds_read_b128 v[88:91], v17 offset:3072
    ds_read_b128 v[92:95], v17 offset:4096
    ds_read_b128 v[96:99], v17 offset:5120
    ds_read_b128 v[100:103], v17 offset:6144
    ds_read_b128 v[104:107], v17 offset:7168
    ds_read_b128 v[108:111], v17 offset:8192
    ds_read_b128 v[112:115], v17 offset:9216
    s_waitcnt lgkmcnt(5)
    s_waitcnt vmcnt(11)
    v_mfma_f32_16x16x32_bf16 v[56:59], v[76:79], v[136:139], v[34:37]
    ds_read_b128 v[116:119], v17 offset:10240
    v_mfma_f32_16x16x32_bf16 v[60:63], v[80:83], v[136:139], v[38:41]
    ds_read_b128 v[120:123], v17 offset:11264
    v_mfma_f32_16x16x32_bf16 v[64:67], v[84:87], v[136:139], v[42:45]
    ds_read_b128 v[124:127], v17 offset:12288
    s_add_u32 s34, s36, 12288
    buffer_load_dwordx4 v[184:187], v16, s[4:7], s34 offen
    v_mfma_f32_16x16x32_bf16 v[68:71], v[88:91], v[136:139], v[46:49]
    ds_read_b128 v[128:131], v17 offset:13312
    v_mfma_f32_16x16x32_bf16 v[72:75], v[92:95], v[136:139], v[50:53]
    ds_read_b128 v[132:135], v17 offset:14336
    s_waitcnt lgkmcnt(5)
    s_waitcnt vmcnt(11)
    v_mfma_f32_16x16x32_bf16 v[56:59], v[96:99], v[140:143], v[56:59]
    ds_read_b128 v[76:79], v17 offset:15360
    v_mfma_f32_16x16x32_bf16 v[60:63], v[100:103], v[140:143], v[60:63]
    ds_read_b128 v[80:83], v17 offset:16384
    v_mfma_f32_16x16x32_bf16 v[64:67], v[104:107], v[140:143], v[64:67]
    ds_read_b128 v[84:87], v17 offset:17408
    s_add_u32 s34, s36, 13312
    buffer_load_dwordx4 v[136:139], v16, s[4:7], s34 offen
    v_mfma_f32_16x16x32_bf16 v[68:71], v[108:111], v[140:143], v[68:71]
    ds_read_b128 v[88:91], v17 offset:18432
    v_mfma_f32_16x16x32_bf16 v[72:75], v[112:115], v[140:143], v[72:75]
    ds_read_b128 v[92:95], v17 offset:19456
    s_waitcnt lgkmcnt(5)
    s_waitcnt vmcnt(11)
    s_waitcnt lgkmcnt(0)
    s_barrier
    v_mfma_f32_16x16x32_bf16 v[56:59], v[116:119], v[144:147], v[56:59]
    ds_read_b128 v[96:99], v18 offset:0
    v_mfma_f32_16x16x32_bf16 v[60:63], v[120:123], v[144:147], v[60:63]
    ds_read_b128 v[100:103], v18 offset:1024
    v_mfma_f32_16x16x32_bf16 v[64:67], v[124:127], v[144:147], v[64:67]
    ds_read_b128 v[104:107], v18 offset:2048
    s_add_u32 s34, s36, 14336
    buffer_load_dwordx4 v[140:143], v16, s[4:7], s34 offen
    v_mfma_f32_16x16x32_bf16 v[68:71], v[128:131], v[144:147], v[68:71]
    ds_read_b128 v[108:111], v18 offset:3072
    v_mfma_f32_16x16x32_bf16 v[72:75], v[132:135], v[144:147], v[72:75]
    ds_read_b128 v[112:115], v18 offset:4096
    s_waitcnt vmcnt(11)
    v_mfma_f32_16x16x32_bf16 v[56:59], v[76:79], v[148:151], v[56:59]
    ds_read_b128 v[116:119], v18 offset:5120
    v_mfma_f32_16x16x32_bf16 v[60:63], v[80:83], v[148:151], v[60:63]
    ds_read_b128 v[120:123], v18 offset:6144
    v_mfma_f32_16x16x32_bf16 v[64:67], v[84:87], v[148:151], v[64:67]
    ds_read_b128 v[124:127], v18 offset:7168
    s_add_u32 s34, s36, 15360
    buffer_load_dwordx4 v[144:147], v16, s[4:7], s34 offen
    v_mfma_f32_16x16x32_bf16 v[68:71], v[88:91], v[148:151], v[68:71]
    ds_read_b128 v[128:131], v18 offset:8192
    v_mfma_f32_16x16x32_bf16 v[72:75], v[92:95], v[148:151], v[72:75]
    ds_read_b128 v[132:135], v18 offset:9216
    s_waitcnt lgkmcnt(5)
    s_waitcnt vmcnt(11)
    v_mfma_f32_16x16x32_bf16 v[56:59], v[96:99], v[152:155], v[56:59]
    ds_read_b128 v[76:79], v18 offset:10240
    v_mfma_f32_16x16x32_bf16 v[60:63], v[100:103], v[152:155], v[60:63]
    ds_read_b128 v[80:83], v18 offset:11264
    v_mfma_f32_16x16x32_bf16 v[64:67], v[104:107], v[152:155], v[64:67]
    ds_read_b128 v[84:87], v18 offset:12288
    s_add_u32 s34, s36, 16384
    buffer_load_dwordx4 v[148:151], v16, s[4:7], s34 offen
    v_mfma_f32_16x16x32_bf16 v[68:71], v[108:111], v[152:155], v[68:71]
    ds_read_b128 v[88:91], v18 offset:13312
    v_mfma_f32_16x16x32_bf16 v[72:75], v[112:115], v[152:155], v[72:75]
    ds_read_b128 v[92:95], v18 offset:14336
    s_waitcnt lgkmcnt(5)
    s_waitcnt vmcnt(11)
    v_mfma_f32_16x16x32_bf16 v[56:59], v[116:119], v[156:159], v[56:59]
    ds_read_b128 v[96:99], v18 offset:15360
    v_mfma_f32_16x16x32_bf16 v[60:63], v[120:123], v[156:159], v[60:63]
    ds_read_b128 v[100:103], v18 offset:16384
    v_mfma_f32_16x16x32_bf16 v[64:67], v[124:127], v[156:159], v[64:67]
    ds_read_b128 v[104:107], v18 offset:17408
    s_add_u32 s34, s36, 17408
    buffer_load_dwordx4 v[152:155], v16, s[4:7], s34 offen
    v_mfma_f32_16x16x32_bf16 v[68:71], v[128:131], v[156:159], v[68:71]
    ds_read_b128 v[108:111], v18 offset:18432
    v_mfma_f32_16x16x32_bf16 v[72:75], v[132:135], v[156:159], v[72:75]
    ds_read_b128 v[112:115], v18 offset:19456
    s_waitcnt lgkmcnt(5)
    s_waitcnt vmcnt(11)
    s_waitcnt lgkmcnt(0)
    s_barrier
    v_mfma_f32_16x16x32_bf16 v[56:59], v[76:79], v[160:163], v[56:59]
    ds_read_b128 v[116:119], v19 offset:0
    v_mfma_f32_16x16x32_bf16 v[60:63], v[80:83], v[160:163], v[60:63]
    ds_read_b128 v[120:123], v19 offset:1024
    v_mfma_f32_16x16x32_bf16 v[64:67], v[84:87], v[160:163], v[64:67]
    ds_read_b128 v[124:127], v19 offset:2048
    s_add_u32 s34, s36, 18432
    buffer_load_dwordx4 v[156:159], v16, s[4:7], s34 offen
    v_mfma_f32_16x16x32_bf16 v[68:71], v[88:91], v[160:163], v[68:71]
    ds_read_b128 v[128:131], v19 offset:3072
    v_mfma_f32_16x16x32_bf16 v[72:75], v[92:95], v[160:163], v[72:75]
    ds_read_b128 v[132:135], v19 offset:4096
    s_waitcnt vmcnt(11)
    v_mfma_f32_16x16x32_bf16 v[56:59], v[96:99], v[164:167], v[56:59]
    ds_read_b128 v[76:79], v19 offset:5120
    v_mfma_f32_16x16x32_bf16 v[60:63], v[100:103], v[164:167], v[60:63]
    ds_read_b128 v[80:83], v19 offset:6144
    v_mfma_f32_16x16x32_bf16 v[64:67], v[104:107], v[164:167], v[64:67]
    ds_read_b128 v[84:87], v19 offset:7168
    s_add_u32 s34, s36, 19456
    buffer_load_dwordx4 v[160:163], v16, s[4:7], s34 offen
    v_mfma_f32_16x16x32_bf16 v[68:71], v[108:111], v[164:167], v[68:71]
    ds_read_b128 v[88:91], v19 offset:8192
    v_mfma_f32_16x16x32_bf16 v[72:75], v[112:115], v[164:167], v[72:75]
    ds_read_b128 v[92:95], v19 offset:9216
    s_waitcnt lgkmcnt(5)
    s_waitcnt vmcnt(11)
    v_mfma_f32_16x16x32_bf16 v[56:59], v[116:119], v[168:171], v[56:59]
    ds_read_b128 v[96:99], v19 offset:10240
    v_mfma_f32_16x16x32_bf16 v[60:63], v[120:123], v[168:171], v[60:63]
    ds_read_b128 v[100:103], v19 offset:11264
    v_mfma_f32_16x16x32_bf16 v[64:67], v[124:127], v[168:171], v[64:67]
    ds_read_b128 v[104:107], v19 offset:12288
    s_add_u32 s34, s36, 20480
    buffer_load_dwordx4 v[164:167], v16, s[4:7], s34 offen
    v_mfma_f32_16x16x32_bf16 v[68:71], v[128:131], v[168:171], v[68:71]
    ds_read_b128 v[108:111], v19 offset:13312
    v_mfma_f32_16x16x32_bf16 v[72:75], v[132:135], v[168:171], v[72:75]
    ds_read_b128 v[112:115], v19 offset:14336
    s_waitcnt lgkmcnt(5)
    s_waitcnt vmcnt(11)
    v_mfma_f32_16x16x32_bf16 v[56:59], v[76:79], v[172:175], v[56:59]
    ds_read_b128 v[116:119], v19 offset:15360
    v_mfma_f32_16x16x32_bf16 v[60:63], v[80:83], v[172:175], v[60:63]
    ds_read_b128 v[120:123], v19 offset:16384
    v_mfma_f32_16x16x32_bf16 v[64:67], v[84:87], v[172:175], v[64:67]
    ds_read_b128 v[124:127], v19 offset:17408
    s_add_u32 s34, s36, 21504
    buffer_load_dwordx4 v[168:171], v16, s[4:7], s34 offen
    v_mfma_f32_16x16x32_bf16 v[68:71], v[88:91], v[172:175], v[68:71]
    ds_read_b128 v[128:131], v19 offset:18432
    v_mfma_f32_16x16x32_bf16 v[72:75], v[92:95], v[172:175], v[72:75]
    ds_read_b128 v[132:135], v19 offset:19456
    s_waitcnt lgkmcnt(5)
    s_waitcnt vmcnt(11)
    s_waitcnt lgkmcnt(0)
    s_barrier
    v_mfma_f32_16x16x32_bf16 v[56:59], v[96:99], v[176:179], v[56:59]
    ds_read_b128 v[76:79], v20 offset:0
    v_mfma_f32_16x16x32_bf16 v[60:63], v[100:103], v[176:179], v[60:63]
    ds_read_b128 v[80:83], v20 offset:1024
    v_mfma_f32_16x16x32_bf16 v[64:67], v[104:107], v[176:179], v[64:67]
    ds_read_b128 v[84:87], v20 offset:2048
    s_add_u32 s34, s36, 22528
    buffer_load_dwordx4 v[172:175], v16, s[4:7], s34 offen
    v_mfma_f32_16x16x32_bf16 v[68:71], v[108:111], v[176:179], v[68:71]
    ds_read_b128 v[88:91], v20 offset:3072
    v_mfma_f32_16x16x32_bf16 v[72:75], v[112:115], v[176:179], v[72:75]
    ds_read_b128 v[92:95], v20 offset:4096
    s_waitcnt vmcnt(11)
    v_mfma_f32_16x16x32_bf16 v[56:59], v[116:119], v[180:183], v[56:59]
    ds_read_b128 v[96:99], v20 offset:5120
    v_mfma_f32_16x16x32_bf16 v[60:63], v[120:123], v[180:183], v[60:63]
    ds_read_b128 v[100:103], v20 offset:6144
    v_mfma_f32_16x16x32_bf16 v[64:67], v[124:127], v[180:183], v[64:67]
    ds_read_b128 v[104:107], v20 offset:7168
    s_add_u32 s34, s36, 23552
    buffer_load_dwordx4 v[176:179], v16, s[4:7], s34 offen
    v_mfma_f32_16x16x32_bf16 v[68:71], v[128:131], v[180:183], v[68:71]
    ds_read_b128 v[108:111], v20 offset:8192
    v_mfma_f32_16x16x32_bf16 v[72:75], v[132:135], v[180:183], v[72:75]
    ds_read_b128 v[112:115], v20 offset:9216
    s_waitcnt lgkmcnt(5)
    s_waitcnt vmcnt(11)
    v_mfma_f32_16x16x32_bf16 v[56:59], v[76:79], v[184:187], v[56:59]
    ds_read_b128 v[116:119], v20 offset:10240
    v_mfma_f32_16x16x32_bf16 v[60:63], v[80:83], v[184:187], v[60:63]
    ds_read_b128 v[120:123], v20 offset:11264
    v_mfma_f32_16x16x32_bf16 v[64:67], v[84:87], v[184:187], v[64:67]
    ds_read_b128 v[124:127], v20 offset:12288
    s_add_u32 s34, s36, 24576
    buffer_load_dwordx4 v[180:183], v16, s[4:7], s34 offen
    v_mfma_f32_16x16x32_bf16 v[68:71], v[88:91], v[184:187], v[68:71]
    ds_read_b128 v[128:131], v20 offset:13312
    v_mfma_f32_16x16x32_bf16 v[72:75], v[92:95], v[184:187], v[72:75]
    ds_read_b128 v[132:135], v20 offset:14336
    s_waitcnt lgkmcnt(5)
    s_waitcnt vmcnt(11)
    v_mfma_f32_16x16x32_bf16 v[56:59], v[96:99], v[136:139], v[56:59]
    ds_read_b128 v[76:79], v20 offset:15360
    v_mfma_f32_16x16x32_bf16 v[60:63], v[100:103], v[136:139], v[60:63]
    ds_read_b128 v[80:83], v20 offset:16384
    v_mfma_f32_16x16x32_bf16 v[64:67], v[104:107], v[136:139], v[64:67]
    ds_read_b128 v[84:87], v20 offset:17408
    s_add_u32 s34, s36, 25600
    buffer_load_dwordx4 v[184:187], v16, s[4:7], s34 offen
    v_mfma_f32_16x16x32_bf16 v[68:71], v[108:111], v[136:139], v[68:71]
    ds_read_b128 v[88:91], v20 offset:18432
    v_mfma_f32_16x16x32_bf16 v[72:75], v[112:115], v[136:139], v[72:75]
    ds_read_b128 v[92:95], v20 offset:19456
    s_waitcnt lgkmcnt(5)
    s_waitcnt vmcnt(11)
    s_waitcnt lgkmcnt(0)
    s_barrier
    v_mfma_f32_16x16x32_bf16 v[56:59], v[116:119], v[140:143], v[56:59]
    ds_read_b128 v[96:99], v21 offset:0
    v_mfma_f32_16x16x32_bf16 v[60:63], v[120:123], v[140:143], v[60:63]
    ds_read_b128 v[100:103], v21 offset:1024
    v_mfma_f32_16x16x32_bf16 v[64:67], v[124:127], v[140:143], v[64:67]
    ds_read_b128 v[104:107], v21 offset:2048
    s_add_u32 s34, s36, 26624
    buffer_load_dwordx4 v[136:139], v16, s[4:7], s34 offen
    v_mfma_f32_16x16x32_bf16 v[68:71], v[128:131], v[140:143], v[68:71]
    ds_read_b128 v[108:111], v21 offset:3072
    v_mfma_f32_16x16x32_bf16 v[72:75], v[132:135], v[140:143], v[72:75]
    ds_read_b128 v[112:115], v21 offset:4096
    s_waitcnt vmcnt(11)
    v_mfma_f32_16x16x32_bf16 v[56:59], v[76:79], v[144:147], v[56:59]
    ds_read_b128 v[116:119], v21 offset:5120
    v_mfma_f32_16x16x32_bf16 v[60:63], v[80:83], v[144:147], v[60:63]
    ds_read_b128 v[120:123], v21 offset:6144
    v_mfma_f32_16x16x32_bf16 v[64:67], v[84:87], v[144:147], v[64:67]
    ds_read_b128 v[124:127], v21 offset:7168
    s_add_u32 s34, s36, 27648
    buffer_load_dwordx4 v[140:143], v16, s[4:7], s34 offen
    v_mfma_f32_16x16x32_bf16 v[68:71], v[88:91], v[144:147], v[68:71]
    ds_read_b128 v[128:131], v21 offset:8192
    v_mfma_f32_16x16x32_bf16 v[72:75], v[92:95], v[144:147], v[72:75]
    ds_read_b128 v[132:135], v21 offset:9216
    s_waitcnt lgkmcnt(5)
    s_waitcnt vmcnt(11)
    v_mfma_f32_16x16x32_bf16 v[56:59], v[96:99], v[148:151], v[56:59]
    ds_read_b128 v[76:79], v21 offset:10240
    v_mfma_f32_16x16x32_bf16 v[60:63], v[100:103], v[148:151], v[60:63]
    ds_read_b128 v[80:83], v21 offset:11264
    v_mfma_f32_16x16x32_bf16 v[64:67], v[104:107], v[148:151], v[64:67]
    ds_read_b128 v[84:87], v21 offset:12288
    s_add_u32 s34, s36, 28672
    buffer_load_dwordx4 v[144:147], v16, s[4:7], s34 offen
    v_mfma_f32_16x16x32_bf16 v[68:71], v[108:111], v[148:151], v[68:71]
    ds_read_b128 v[88:91], v21 offset:13312
    v_mfma_f32_16x16x32_bf16 v[72:75], v[112:115], v[148:151], v[72:75]
    ds_read_b128 v[92:95], v21 offset:14336
    s_waitcnt lgkmcnt(5)
    s_waitcnt vmcnt(11)
    v_mfma_f32_16x16x32_bf16 v[56:59], v[116:119], v[152:155], v[56:59]
    ds_read_b128 v[96:99], v21 offset:15360
    v_mfma_f32_16x16x32_bf16 v[60:63], v[120:123], v[152:155], v[60:63]
    ds_read_b128 v[100:103], v21 offset:16384
    v_mfma_f32_16x16x32_bf16 v[64:67], v[124:127], v[152:155], v[64:67]
    ds_read_b128 v[104:107], v21 offset:17408
    s_add_u32 s34, s36, 29696
    buffer_load_dwordx4 v[148:151], v16, s[4:7], s34 offen
    v_mfma_f32_16x16x32_bf16 v[68:71], v[128:131], v[152:155], v[68:71]
    ds_read_b128 v[108:111], v21 offset:18432
    v_mfma_f32_16x16x32_bf16 v[72:75], v[132:135], v[152:155], v[72:75]
    ds_read_b128 v[112:115], v21 offset:19456
    s_waitcnt lgkmcnt(5)
    s_waitcnt vmcnt(11)
    s_waitcnt lgkmcnt(0)
    s_barrier
    v_mfma_f32_16x16x32_bf16 v[56:59], v[76:79], v[156:159], v[56:59]
    ds_read_b128 v[116:119], v22 offset:0
    v_mfma_f32_16x16x32_bf16 v[60:63], v[80:83], v[156:159], v[60:63]
    ds_read_b128 v[120:123], v22 offset:1024
    v_mfma_f32_16x16x32_bf16 v[64:67], v[84:87], v[156:159], v[64:67]
    ds_read_b128 v[124:127], v22 offset:2048
    s_add_u32 s34, s36, 30720
    buffer_load_dwordx4 v[152:155], v16, s[4:7], s34 offen
    v_mfma_f32_16x16x32_bf16 v[68:71], v[88:91], v[156:159], v[68:71]
    ds_read_b128 v[128:131], v22 offset:3072
    v_mfma_f32_16x16x32_bf16 v[72:75], v[92:95], v[156:159], v[72:75]
    ds_read_b128 v[132:135], v22 offset:4096
    s_waitcnt vmcnt(11)
    v_mfma_f32_16x16x32_bf16 v[56:59], v[96:99], v[160:163], v[56:59]
    ds_read_b128 v[76:79], v22 offset:5120
    v_mfma_f32_16x16x32_bf16 v[60:63], v[100:103], v[160:163], v[60:63]
    ds_read_b128 v[80:83], v22 offset:6144
    v_mfma_f32_16x16x32_bf16 v[64:67], v[104:107], v[160:163], v[64:67]
    ds_read_b128 v[84:87], v22 offset:7168
    s_add_u32 s34, s36, 31744
    buffer_load_dwordx4 v[156:159], v16, s[4:7], s34 offen
    v_mfma_f32_16x16x32_bf16 v[68:71], v[108:111], v[160:163], v[68:71]
    ds_read_b128 v[88:91], v22 offset:8192
    v_mfma_f32_16x16x32_bf16 v[72:75], v[112:115], v[160:163], v[72:75]
    ds_read_b128 v[92:95], v22 offset:9216
    s_waitcnt lgkmcnt(5)
    s_waitcnt vmcnt(11)
    v_mfma_f32_16x16x32_bf16 v[56:59], v[116:119], v[164:167], v[56:59]
    ds_read_b128 v[96:99], v22 offset:10240
    v_mfma_f32_16x16x32_bf16 v[60:63], v[120:123], v[164:167], v[60:63]
    ds_read_b128 v[100:103], v22 offset:11264
    v_mfma_f32_16x16x32_bf16 v[64:67], v[124:127], v[164:167], v[64:67]
    ds_read_b128 v[104:107], v22 offset:12288
    s_add_u32 s34, s36, 32768
    buffer_load_dwordx4 v[160:163], v16, s[4:7], s34 offen
    v_mfma_f32_16x16x32_bf16 v[68:71], v[128:131], v[164:167], v[68:71]
    ds_read_b128 v[108:111], v22 offset:13312
    v_mfma_f32_16x16x32_bf16 v[72:75], v[132:135], v[164:167], v[72:75]
    ds_read_b128 v[112:115], v22 offset:14336
    s_waitcnt lgkmcnt(5)
    s_waitcnt vmcnt(11)
    v_mfma_f32_16x16x32_bf16 v[56:59], v[76:79], v[168:171], v[56:59]
    ds_read_b128 v[116:119], v22 offset:15360
    v_mfma_f32_16x16x32_bf16 v[60:63], v[80:83], v[168:171], v[60:63]
    ds_read_b128 v[120:123], v22 offset:16384
    v_mfma_f32_16x16x32_bf16 v[64:67], v[84:87], v[168:171], v[64:67]
    ds_read_b128 v[124:127], v22 offset:17408
    s_add_u32 s34, s36, 33792
    buffer_load_dwordx4 v[164:167], v16, s[4:7], s34 offen
    v_mfma_f32_16x16x32_bf16 v[68:71], v[88:91], v[168:171], v[68:71]
    ds_read_b128 v[128:131], v22 offset:18432
    v_mfma_f32_16x16x32_bf16 v[72:75], v[92:95], v[168:171], v[72:75]
    ds_read_b128 v[132:135], v22 offset:19456
    s_waitcnt lgkmcnt(5)
    s_waitcnt vmcnt(11)
    s_waitcnt lgkmcnt(0)
    s_barrier
    v_mfma_f32_16x16x32_bf16 v[56:59], v[96:99], v[172:175], v[56:59]
    ds_read_b128 v[76:79], v23 offset:0
    v_mfma_f32_16x16x32_bf16 v[60:63], v[100:103], v[172:175], v[60:63]
    ds_read_b128 v[80:83], v23 offset:1024
    v_mfma_f32_16x16x32_bf16 v[64:67], v[104:107], v[172:175], v[64:67]
    ds_read_b128 v[84:87], v23 offset:2048
    s_add_u32 s34, s36, 34816
    buffer_load_dwordx4 v[168:171], v16, s[4:7], s34 offen
    v_mfma_f32_16x16x32_bf16 v[68:71], v[108:111], v[172:175], v[68:71]
    ds_read_b128 v[88:91], v23 offset:3072
    v_mfma_f32_16x16x32_bf16 v[72:75], v[112:115], v[172:175], v[72:75]
    ds_read_b128 v[92:95], v23 offset:4096
    s_waitcnt vmcnt(11)
    v_mfma_f32_16x16x32_bf16 v[56:59], v[116:119], v[176:179], v[56:59]
    ds_read_b128 v[96:99], v23 offset:5120
    v_mfma_f32_16x16x32_bf16 v[60:63], v[120:123], v[176:179], v[60:63]
    ds_read_b128 v[100:103], v23 offset:6144
    v_mfma_f32_16x16x32_bf16 v[64:67], v[124:127], v[176:179], v[64:67]
    ds_read_b128 v[104:107], v23 offset:7168
    s_add_u32 s34, s36, 35840
    buffer_load_dwordx4 v[172:175], v16, s[4:7], s34 offen
    v_mfma_f32_16x16x32_bf16 v[68:71], v[128:131], v[176:179], v[68:71]
    ds_read_b128 v[108:111], v23 offset:8192
    v_mfma_f32_16x16x32_bf16 v[72:75], v[132:135], v[176:179], v[72:75]
    ds_read_b128 v[112:115], v23 offset:9216
    s_waitcnt lgkmcnt(5)
    s_waitcnt vmcnt(11)
    v_mfma_f32_16x16x32_bf16 v[56:59], v[76:79], v[180:183], v[56:59]
    ds_read_b128 v[116:119], v23 offset:10240
    v_mfma_f32_16x16x32_bf16 v[60:63], v[80:83], v[180:183], v[60:63]
    ds_read_b128 v[120:123], v23 offset:11264
    v_mfma_f32_16x16x32_bf16 v[64:67], v[84:87], v[180:183], v[64:67]
    ds_read_b128 v[124:127], v23 offset:12288
    s_add_u32 s34, s36, 36864
    buffer_load_dwordx4 v[176:179], v16, s[4:7], s34 offen
    v_mfma_f32_16x16x32_bf16 v[68:71], v[88:91], v[180:183], v[68:71]
    ds_read_b128 v[128:131], v23 offset:13312
    v_mfma_f32_16x16x32_bf16 v[72:75], v[92:95], v[180:183], v[72:75]
    ds_read_b128 v[132:135], v23 offset:14336
    s_waitcnt lgkmcnt(5)
    s_waitcnt vmcnt(11)
    v_mfma_f32_16x16x32_bf16 v[56:59], v[96:99], v[184:187], v[56:59]
    ds_read_b128 v[76:79], v23 offset:15360
    v_mfma_f32_16x16x32_bf16 v[60:63], v[100:103], v[184:187], v[60:63]
    ds_read_b128 v[80:83], v23 offset:16384
    v_mfma_f32_16x16x32_bf16 v[64:67], v[104:107], v[184:187], v[64:67]
    ds_read_b128 v[84:87], v23 offset:17408
    s_add_u32 s34, s36, 37888
    buffer_load_dwordx4 v[180:183], v16, s[4:7], s34 offen
    v_mfma_f32_16x16x32_bf16 v[68:71], v[108:111], v[184:187], v[68:71]
    ds_read_b128 v[88:91], v23 offset:18432
    v_mfma_f32_16x16x32_bf16 v[72:75], v[112:115], v[184:187], v[72:75]
    ds_read_b128 v[92:95], v23 offset:19456
    s_waitcnt lgkmcnt(5)
    s_waitcnt vmcnt(11)
    s_waitcnt lgkmcnt(0)
    s_barrier
    v_mfma_f32_16x16x32_bf16 v[56:59], v[116:119], v[136:139], v[56:59]
    ds_read_b128 v[96:99], v17 offset:0
    v_mfma_f32_16x16x32_bf16 v[60:63], v[120:123], v[136:139], v[60:63]
    ds_read_b128 v[100:103], v17 offset:1024
    v_mfma_f32_16x16x32_bf16 v[64:67], v[124:127], v[136:139], v[64:67]
    ds_read_b128 v[104:107], v17 offset:2048
    s_add_u32 s34, s36, 38912
    buffer_load_dwordx4 v[184:187], v16, s[4:7], s34 offen
    v_mfma_f32_16x16x32_bf16 v[68:71], v[128:131], v[136:139], v[68:71]
    ds_read_b128 v[108:111], v17 offset:3072
    v_mfma_f32_16x16x32_bf16 v[72:75], v[132:135], v[136:139], v[72:75]
    ds_read_b128 v[112:115], v17 offset:4096
    s_waitcnt vmcnt(11)
    v_mfma_f32_16x16x32_bf16 v[56:59], v[76:79], v[140:143], v[56:59]
    ds_read_b128 v[116:119], v17 offset:5120
    v_mfma_f32_16x16x32_bf16 v[60:63], v[80:83], v[140:143], v[60:63]
    ds_read_b128 v[120:123], v17 offset:6144
    v_mfma_f32_16x16x32_bf16 v[64:67], v[84:87], v[140:143], v[64:67]
    ds_read_b128 v[124:127], v17 offset:7168
    s_add_u32 s34, s36, 39936
    buffer_load_dwordx4 v[136:139], v16, s[4:7], s34 offen
    v_mfma_f32_16x16x32_bf16 v[68:71], v[88:91], v[140:143], v[68:71]
    ds_read_b128 v[128:131], v17 offset:8192
    v_mfma_f32_16x16x32_bf16 v[72:75], v[92:95], v[140:143], v[72:75]
    ds_read_b128 v[132:135], v17 offset:9216
    s_waitcnt lgkmcnt(5)
    s_waitcnt vmcnt(11)
    v_mfma_f32_16x16x32_bf16 v[56:59], v[96:99], v[144:147], v[56:59]
    ds_read_b128 v[76:79], v17 offset:10240
    v_mfma_f32_16x16x32_bf16 v[60:63], v[100:103], v[144:147], v[60:63]
    ds_read_b128 v[80:83], v17 offset:11264
    v_mfma_f32_16x16x32_bf16 v[64:67], v[104:107], v[144:147], v[64:67]
    ds_read_b128 v[84:87], v17 offset:12288
    s_add_u32 s34, s36, 40960
    buffer_load_dwordx4 v[140:143], v16, s[4:7], s34 offen
    v_mfma_f32_16x16x32_bf16 v[68:71], v[108:111], v[144:147], v[68:71]
    ds_read_b128 v[88:91], v17 offset:13312
    v_mfma_f32_16x16x32_bf16 v[72:75], v[112:115], v[144:147], v[72:75]
    ds_read_b128 v[92:95], v17 offset:14336
    s_waitcnt lgkmcnt(5)
    s_waitcnt vmcnt(11)
    v_mfma_f32_16x16x32_bf16 v[56:59], v[116:119], v[148:151], v[56:59]
    ds_read_b128 v[96:99], v17 offset:15360
    v_mfma_f32_16x16x32_bf16 v[60:63], v[120:123], v[148:151], v[60:63]
    ds_read_b128 v[100:103], v17 offset:16384
    v_mfma_f32_16x16x32_bf16 v[64:67], v[124:127], v[148:151], v[64:67]
    ds_read_b128 v[104:107], v17 offset:17408
    s_add_u32 s34, s36, 41984
    buffer_load_dwordx4 v[144:147], v16, s[4:7], s34 offen
    v_mfma_f32_16x16x32_bf16 v[68:71], v[128:131], v[148:151], v[68:71]
    ds_read_b128 v[108:111], v17 offset:18432
    v_mfma_f32_16x16x32_bf16 v[72:75], v[132:135], v[148:151], v[72:75]
    ds_read_b128 v[112:115], v17 offset:19456
    s_waitcnt lgkmcnt(5)
    s_waitcnt vmcnt(11)
    s_waitcnt lgkmcnt(0)
    s_barrier
    v_mfma_f32_16x16x32_bf16 v[56:59], v[76:79], v[152:155], v[56:59]
    ds_read_b128 v[116:119], v18 offset:0
    v_mfma_f32_16x16x32_bf16 v[60:63], v[80:83], v[152:155], v[60:63]
    ds_read_b128 v[120:123], v18 offset:1024
    v_mfma_f32_16x16x32_bf16 v[64:67], v[84:87], v[152:155], v[64:67]
    ds_read_b128 v[124:127], v18 offset:2048
    s_add_u32 s34, s36, 43008
    buffer_load_dwordx4 v[148:151], v16, s[4:7], s34 offen
    v_mfma_f32_16x16x32_bf16 v[68:71], v[88:91], v[152:155], v[68:71]
    ds_read_b128 v[128:131], v18 offset:3072
    v_mfma_f32_16x16x32_bf16 v[72:75], v[92:95], v[152:155], v[72:75]
    ds_read_b128 v[132:135], v18 offset:4096
    s_waitcnt vmcnt(11)
    v_mfma_f32_16x16x32_bf16 v[56:59], v[96:99], v[156:159], v[56:59]
    ds_read_b128 v[76:79], v18 offset:5120
    v_mfma_f32_16x16x32_bf16 v[60:63], v[100:103], v[156:159], v[60:63]
    ds_read_b128 v[80:83], v18 offset:6144
    v_mfma_f32_16x16x32_bf16 v[64:67], v[104:107], v[156:159], v[64:67]
    ds_read_b128 v[84:87], v18 offset:7168
    s_add_u32 s34, s36, 44032
    buffer_load_dwordx4 v[152:155], v16, s[4:7], s34 offen
    v_mfma_f32_16x16x32_bf16 v[68:71], v[108:111], v[156:159], v[68:71]
    ds_read_b128 v[88:91], v18 offset:8192
    v_mfma_f32_16x16x32_bf16 v[72:75], v[112:115], v[156:159], v[72:75]
    ds_read_b128 v[92:95], v18 offset:9216
    s_waitcnt lgkmcnt(5)
    s_waitcnt vmcnt(11)
    v_mfma_f32_16x16x32_bf16 v[56:59], v[116:119], v[160:163], v[56:59]
    ds_read_b128 v[96:99], v18 offset:10240
    v_mfma_f32_16x16x32_bf16 v[60:63], v[120:123], v[160:163], v[60:63]
    ds_read_b128 v[100:103], v18 offset:11264
    v_mfma_f32_16x16x32_bf16 v[64:67], v[124:127], v[160:163], v[64:67]
    ds_read_b128 v[104:107], v18 offset:12288
    s_add_u32 s34, s36, 45056
    buffer_load_dwordx4 v[156:159], v16, s[4:7], s34 offen
    v_mfma_f32_16x16x32_bf16 v[68:71], v[128:131], v[160:163], v[68:71]
    ds_read_b128 v[108:111], v18 offset:13312
    v_mfma_f32_16x16x32_bf16 v[72:75], v[132:135], v[160:163], v[72:75]
    ds_read_b128 v[112:115], v18 offset:14336
    s_waitcnt lgkmcnt(5)
    s_waitcnt vmcnt(11)
    v_mfma_f32_16x16x32_bf16 v[56:59], v[76:79], v[164:167], v[56:59]
    ds_read_b128 v[116:119], v18 offset:15360
    v_mfma_f32_16x16x32_bf16 v[60:63], v[80:83], v[164:167], v[60:63]
    ds_read_b128 v[120:123], v18 offset:16384
    v_mfma_f32_16x16x32_bf16 v[64:67], v[84:87], v[164:167], v[64:67]
    ds_read_b128 v[124:127], v18 offset:17408
    s_add_u32 s34, s36, 46080
    buffer_load_dwordx4 v[160:163], v16, s[4:7], s34 offen
    v_mfma_f32_16x16x32_bf16 v[68:71], v[88:91], v[164:167], v[68:71]
    ds_read_b128 v[128:131], v18 offset:18432
    v_mfma_f32_16x16x32_bf16 v[72:75], v[92:95], v[164:167], v[72:75]
    ds_read_b128 v[132:135], v18 offset:19456
    s_waitcnt lgkmcnt(5)
    s_waitcnt vmcnt(11)
    s_waitcnt lgkmcnt(0)
    s_barrier
    v_mfma_f32_16x16x32_bf16 v[56:59], v[96:99], v[168:171], v[56:59]
    ds_read_b128 v[76:79], v19 offset:0
    v_mfma_f32_16x16x32_bf16 v[60:63], v[100:103], v[168:171], v[60:63]
    ds_read_b128 v[80:83], v19 offset:1024
    v_mfma_f32_16x16x32_bf16 v[64:67], v[104:107], v[168:171], v[64:67]
    ds_read_b128 v[84:87], v19 offset:2048
    s_add_u32 s34, s36, 47104
    buffer_load_dwordx4 v[164:167], v16, s[4:7], s34 offen
    v_mfma_f32_16x16x32_bf16 v[68:71], v[108:111], v[168:171], v[68:71]
    ds_read_b128 v[88:91], v19 offset:3072
    v_mfma_f32_16x16x32_bf16 v[72:75], v[112:115], v[168:171], v[72:75]
    ds_read_b128 v[92:95], v19 offset:4096
    s_waitcnt vmcnt(11)
    v_mfma_f32_16x16x32_bf16 v[56:59], v[116:119], v[172:175], v[56:59]
    ds_read_b128 v[96:99], v19 offset:5120
    v_mfma_f32_16x16x32_bf16 v[60:63], v[120:123], v[172:175], v[60:63]
    ds_read_b128 v[100:103], v19 offset:6144
    v_mfma_f32_16x16x32_bf16 v[64:67], v[124:127], v[172:175], v[64:67]
    ds_read_b128 v[104:107], v19 offset:7168
    s_add_u32 s34, s36, 48128
    buffer_load_dwordx4 v[168:171], v16, s[4:7], s34 offen
    v_mfma_f32_16x16x32_bf16 v[68:71], v[128:131], v[172:175], v[68:71]
    ds_read_b128 v[108:111], v19 offset:8192
    v_mfma_f32_16x16x32_bf16 v[72:75], v[132:135], v[172:175], v[72:75]
    ds_read_b128 v[112:115], v19 offset:9216
    s_waitcnt lgkmcnt(5)
    s_waitcnt vmcnt(11)
    v_mfma_f32_16x16x32_bf16 v[56:59], v[76:79], v[176:179], v[56:59]
    ds_read_b128 v[116:119], v19 offset:10240
    v_mfma_f32_16x16x32_bf16 v[60:63], v[80:83], v[176:179], v[60:63]
    ds_read_b128 v[120:123], v19 offset:11264
    v_mfma_f32_16x16x32_bf16 v[64:67], v[84:87], v[176:179], v[64:67]
    ds_read_b128 v[124:127], v19 offset:12288
    s_add_u32 s34, s36, 49152
    buffer_load_dwordx4 v[172:175], v16, s[4:7], s34 offen
    v_mfma_f32_16x16x32_bf16 v[68:71], v[88:91], v[176:179], v[68:71]
    ds_read_b128 v[128:131], v19 offset:13312
    v_mfma_f32_16x16x32_bf16 v[72:75], v[92:95], v[176:179], v[72:75]
    ds_read_b128 v[132:135], v19 offset:14336
    s_waitcnt lgkmcnt(5)
    s_waitcnt vmcnt(11)
    v_mfma_f32_16x16x32_bf16 v[56:59], v[96:99], v[180:183], v[56:59]
    ds_read_b128 v[76:79], v19 offset:15360
    v_mfma_f32_16x16x32_bf16 v[60:63], v[100:103], v[180:183], v[60:63]
    ds_read_b128 v[80:83], v19 offset:16384
    v_mfma_f32_16x16x32_bf16 v[64:67], v[104:107], v[180:183], v[64:67]
    ds_read_b128 v[84:87], v19 offset:17408
    s_add_u32 s34, s36, 50176
    buffer_load_dwordx4 v[176:179], v16, s[4:7], s34 offen
    v_mfma_f32_16x16x32_bf16 v[68:71], v[108:111], v[180:183], v[68:71]
    ds_read_b128 v[88:91], v19 offset:18432
    v_mfma_f32_16x16x32_bf16 v[72:75], v[112:115], v[180:183], v[72:75]
    ds_read_b128 v[92:95], v19 offset:19456
    s_waitcnt lgkmcnt(5)
    s_waitcnt vmcnt(11)
    s_waitcnt lgkmcnt(0)
    s_barrier
    v_mfma_f32_16x16x32_bf16 v[56:59], v[116:119], v[184:187], v[56:59]
    ds_read_b128 v[96:99], v20 offset:0
    v_mfma_f32_16x16x32_bf16 v[60:63], v[120:123], v[184:187], v[60:63]
    ds_read_b128 v[100:103], v20 offset:1024
    v_mfma_f32_16x16x32_bf16 v[64:67], v[124:127], v[184:187], v[64:67]
    ds_read_b128 v[104:107], v20 offset:2048
    s_add_u32 s34, s36, 51200
    buffer_load_dwordx4 v[180:183], v16, s[4:7], s34 offen
    v_mfma_f32_16x16x32_bf16 v[68:71], v[128:131], v[184:187], v[68:71]
    ds_read_b128 v[108:111], v20 offset:3072
    v_mfma_f32_16x16x32_bf16 v[72:75], v[132:135], v[184:187], v[72:75]
    ds_read_b128 v[112:115], v20 offset:4096
    s_waitcnt vmcnt(11)
    v_mfma_f32_16x16x32_bf16 v[56:59], v[76:79], v[136:139], v[56:59]
    ds_read_b128 v[116:119], v20 offset:5120
    v_mfma_f32_16x16x32_bf16 v[60:63], v[80:83], v[136:139], v[60:63]
    ds_read_b128 v[120:123], v20 offset:6144
    v_mfma_f32_16x16x32_bf16 v[64:67], v[84:87], v[136:139], v[64:67]
    ds_read_b128 v[124:127], v20 offset:7168
    s_add_u32 s34, s36, 52224
    buffer_load_dwordx4 v[184:187], v16, s[4:7], s34 offen
    v_mfma_f32_16x16x32_bf16 v[68:71], v[88:91], v[136:139], v[68:71]
    ds_read_b128 v[128:131], v20 offset:8192
    v_mfma_f32_16x16x32_bf16 v[72:75], v[92:95], v[136:139], v[72:75]
    ds_read_b128 v[132:135], v20 offset:9216
    s_waitcnt lgkmcnt(5)
    s_waitcnt vmcnt(11)
    v_mfma_f32_16x16x32_bf16 v[56:59], v[96:99], v[140:143], v[56:59]
    ds_read_b128 v[76:79], v20 offset:10240
    v_mfma_f32_16x16x32_bf16 v[60:63], v[100:103], v[140:143], v[60:63]
    ds_read_b128 v[80:83], v20 offset:11264
    v_mfma_f32_16x16x32_bf16 v[64:67], v[104:107], v[140:143], v[64:67]
    ds_read_b128 v[84:87], v20 offset:12288
    s_add_u32 s34, s36, 53248
    buffer_load_dwordx4 v[136:139], v16, s[4:7], s34 offen
    v_mfma_f32_16x16x32_bf16 v[68:71], v[108:111], v[140:143], v[68:71]
    ds_read_b128 v[88:91], v20 offset:13312
    v_mfma_f32_16x16x32_bf16 v[72:75], v[112:115], v[140:143], v[72:75]
    ds_read_b128 v[92:95], v20 offset:14336
    s_waitcnt lgkmcnt(5)
    s_waitcnt vmcnt(11)
    v_mfma_f32_16x16x32_bf16 v[56:59], v[116:119], v[144:147], v[56:59]
    ds_read_b128 v[96:99], v20 offset:15360
    v_mfma_f32_16x16x32_bf16 v[60:63], v[120:123], v[144:147], v[60:63]
    ds_read_b128 v[100:103], v20 offset:16384
    v_mfma_f32_16x16x32_bf16 v[64:67], v[124:127], v[144:147], v[64:67]
    ds_read_b128 v[104:107], v20 offset:17408
    s_add_u32 s34, s36, 54272
    buffer_load_dwordx4 v[140:143], v16, s[4:7], s34 offen
    v_mfma_f32_16x16x32_bf16 v[68:71], v[128:131], v[144:147], v[68:71]
    ds_read_b128 v[108:111], v20 offset:18432
    v_mfma_f32_16x16x32_bf16 v[72:75], v[132:135], v[144:147], v[72:75]
    ds_read_b128 v[112:115], v20 offset:19456
    s_waitcnt lgkmcnt(5)
    s_waitcnt vmcnt(11)
    s_waitcnt lgkmcnt(0)
    s_barrier
    v_mfma_f32_16x16x32_bf16 v[56:59], v[76:79], v[148:151], v[56:59]
    ds_read_b128 v[116:119], v21 offset:0
    v_mfma_f32_16x16x32_bf16 v[60:63], v[80:83], v[148:151], v[60:63]
    ds_read_b128 v[120:123], v21 offset:1024
    v_mfma_f32_16x16x32_bf16 v[64:67], v[84:87], v[148:151], v[64:67]
    ds_read_b128 v[124:127], v21 offset:2048
    v_mfma_f32_16x16x32_bf16 v[68:71], v[88:91], v[148:151], v[68:71]
    ds_read_b128 v[128:131], v21 offset:3072
    v_mfma_f32_16x16x32_bf16 v[72:75], v[92:95], v[148:151], v[72:75]
    ds_read_b128 v[132:135], v21 offset:4096
    s_waitcnt vmcnt(10)
    v_mfma_f32_16x16x32_bf16 v[56:59], v[96:99], v[152:155], v[56:59]
    ds_read_b128 v[76:79], v21 offset:5120
    v_mfma_f32_16x16x32_bf16 v[60:63], v[100:103], v[152:155], v[60:63]
    ds_read_b128 v[80:83], v21 offset:6144
    v_mfma_f32_16x16x32_bf16 v[64:67], v[104:107], v[152:155], v[64:67]
    ds_read_b128 v[84:87], v21 offset:7168
    v_mfma_f32_16x16x32_bf16 v[68:71], v[108:111], v[152:155], v[68:71]
    ds_read_b128 v[88:91], v21 offset:8192
    v_mfma_f32_16x16x32_bf16 v[72:75], v[112:115], v[152:155], v[72:75]
    ds_read_b128 v[92:95], v21 offset:9216
    s_waitcnt lgkmcnt(5)
    s_waitcnt vmcnt(9)
    v_mfma_f32_16x16x32_bf16 v[56:59], v[116:119], v[156:159], v[56:59]
    ds_read_b128 v[96:99], v21 offset:10240
    v_mfma_f32_16x16x32_bf16 v[60:63], v[120:123], v[156:159], v[60:63]
    ds_read_b128 v[100:103], v21 offset:11264
    v_mfma_f32_16x16x32_bf16 v[64:67], v[124:127], v[156:159], v[64:67]
    ds_read_b128 v[104:107], v21 offset:12288
    v_mfma_f32_16x16x32_bf16 v[68:71], v[128:131], v[156:159], v[68:71]
    ds_read_b128 v[108:111], v21 offset:13312
    v_mfma_f32_16x16x32_bf16 v[72:75], v[132:135], v[156:159], v[72:75]
    ds_read_b128 v[112:115], v21 offset:14336
    s_waitcnt lgkmcnt(5)
    s_waitcnt vmcnt(8)
    v_mfma_f32_16x16x32_bf16 v[56:59], v[76:79], v[160:163], v[56:59]
    ds_read_b128 v[116:119], v21 offset:15360
    v_mfma_f32_16x16x32_bf16 v[60:63], v[80:83], v[160:163], v[60:63]
    ds_read_b128 v[120:123], v21 offset:16384
    v_mfma_f32_16x16x32_bf16 v[64:67], v[84:87], v[160:163], v[64:67]
    ds_read_b128 v[124:127], v21 offset:17408
    v_mfma_f32_16x16x32_bf16 v[68:71], v[88:91], v[160:163], v[68:71]
    ds_read_b128 v[128:131], v21 offset:18432
    v_mfma_f32_16x16x32_bf16 v[72:75], v[92:95], v[160:163], v[72:75]
    ds_read_b128 v[132:135], v21 offset:19456
    s_waitcnt lgkmcnt(5)
    s_waitcnt vmcnt(7)
    s_waitcnt lgkmcnt(0)
    s_barrier
    v_mfma_f32_16x16x32_bf16 v[56:59], v[96:99], v[164:167], v[56:59]
    ds_read_b128 v[76:79], v22 offset:0
    v_mfma_f32_16x16x32_bf16 v[60:63], v[100:103], v[164:167], v[60:63]
    ds_read_b128 v[80:83], v22 offset:1024
    v_mfma_f32_16x16x32_bf16 v[64:67], v[104:107], v[164:167], v[64:67]
    ds_read_b128 v[84:87], v22 offset:2048
    v_mfma_f32_16x16x32_bf16 v[68:71], v[108:111], v[164:167], v[68:71]
    ds_read_b128 v[88:91], v22 offset:3072
    v_mfma_f32_16x16x32_bf16 v[72:75], v[112:115], v[164:167], v[72:75]
    ds_read_b128 v[92:95], v22 offset:4096
    s_waitcnt vmcnt(6)
    v_mfma_f32_16x16x32_bf16 v[56:59], v[116:119], v[168:171], v[56:59]
    ds_read_b128 v[96:99], v22 offset:5120
    v_mfma_f32_16x16x32_bf16 v[60:63], v[120:123], v[168:171], v[60:63]
    ds_read_b128 v[100:103], v22 offset:6144
    v_mfma_f32_16x16x32_bf16 v[64:67], v[124:127], v[168:171], v[64:67]
    ds_read_b128 v[104:107], v22 offset:7168
    v_mfma_f32_16x16x32_bf16 v[68:71], v[128:131], v[168:171], v[68:71]
    ds_read_b128 v[108:111], v22 offset:8192
    v_mfma_f32_16x16x32_bf16 v[72:75], v[132:135], v[168:171], v[72:75]
    ds_read_b128 v[112:115], v22 offset:9216
    s_waitcnt lgkmcnt(5)
    s_waitcnt vmcnt(5)
    v_mfma_f32_16x16x32_bf16 v[56:59], v[76:79], v[172:175], v[56:59]
    ds_read_b128 v[116:119], v22 offset:10240
    v_mfma_f32_16x16x32_bf16 v[60:63], v[80:83], v[172:175], v[60:63]
    ds_read_b128 v[120:123], v22 offset:11264
    v_mfma_f32_16x16x32_bf16 v[64:67], v[84:87], v[172:175], v[64:67]
    ds_read_b128 v[124:127], v22 offset:12288
    v_mfma_f32_16x16x32_bf16 v[68:71], v[88:91], v[172:175], v[68:71]
    ds_read_b128 v[128:131], v22 offset:13312
    v_mfma_f32_16x16x32_bf16 v[72:75], v[92:95], v[172:175], v[72:75]
    ds_read_b128 v[132:135], v22 offset:14336
    s_waitcnt lgkmcnt(5)
    s_waitcnt vmcnt(4)
    v_mfma_f32_16x16x32_bf16 v[56:59], v[96:99], v[176:179], v[56:59]
    ds_read_b128 v[76:79], v22 offset:15360
    v_mfma_f32_16x16x32_bf16 v[60:63], v[100:103], v[176:179], v[60:63]
    ds_read_b128 v[80:83], v22 offset:16384
    v_mfma_f32_16x16x32_bf16 v[64:67], v[104:107], v[176:179], v[64:67]
    ds_read_b128 v[84:87], v22 offset:17408
    v_mfma_f32_16x16x32_bf16 v[68:71], v[108:111], v[176:179], v[68:71]
    ds_read_b128 v[88:91], v22 offset:18432
    v_mfma_f32_16x16x32_bf16 v[72:75], v[112:115], v[176:179], v[72:75]
    ds_read_b128 v[92:95], v22 offset:19456
    s_waitcnt lgkmcnt(5)
    s_waitcnt vmcnt(3)
    s_waitcnt lgkmcnt(0)
    s_barrier
    v_mfma_f32_16x16x32_bf16 v[56:59], v[116:119], v[180:183], v[56:59]
    ds_read_b128 v[96:99], v23 offset:0
    v_mfma_f32_16x16x32_bf16 v[60:63], v[120:123], v[180:183], v[60:63]
    ds_read_b128 v[100:103], v23 offset:1024
    v_mfma_f32_16x16x32_bf16 v[64:67], v[124:127], v[180:183], v[64:67]
    ds_read_b128 v[104:107], v23 offset:2048
    v_mfma_f32_16x16x32_bf16 v[68:71], v[128:131], v[180:183], v[68:71]
    ds_read_b128 v[108:111], v23 offset:3072
    v_mfma_f32_16x16x32_bf16 v[72:75], v[132:135], v[180:183], v[72:75]
    ds_read_b128 v[112:115], v23 offset:4096
    s_waitcnt vmcnt(2)
    v_mfma_f32_16x16x32_bf16 v[56:59], v[76:79], v[184:187], v[56:59]
    ds_read_b128 v[116:119], v23 offset:5120
    v_mfma_f32_16x16x32_bf16 v[60:63], v[80:83], v[184:187], v[60:63]
    ds_read_b128 v[120:123], v23 offset:6144
    v_mfma_f32_16x16x32_bf16 v[64:67], v[84:87], v[184:187], v[64:67]
    ds_read_b128 v[124:127], v23 offset:7168
    v_mfma_f32_16x16x32_bf16 v[68:71], v[88:91], v[184:187], v[68:71]
    ds_read_b128 v[128:131], v23 offset:8192
    v_mfma_f32_16x16x32_bf16 v[72:75], v[92:95], v[184:187], v[72:75]
    ds_read_b128 v[132:135], v23 offset:9216
    s_waitcnt lgkmcnt(5)
    s_waitcnt vmcnt(1)
    v_mfma_f32_16x16x32_bf16 v[56:59], v[96:99], v[136:139], v[56:59]
    v_mfma_f32_16x16x32_bf16 v[60:63], v[100:103], v[136:139], v[60:63]
    v_mfma_f32_16x16x32_bf16 v[64:67], v[104:107], v[136:139], v[64:67]
    v_mfma_f32_16x16x32_bf16 v[68:71], v[108:111], v[136:139], v[68:71]
    v_mfma_f32_16x16x32_bf16 v[72:75], v[112:115], v[136:139], v[72:75]
    s_waitcnt lgkmcnt(0)
    s_waitcnt vmcnt(0)
    v_mfma_f32_16x16x32_bf16 v[56:59], v[116:119], v[140:143], v[56:59]
    v_mfma_f32_16x16x32_bf16 v[60:63], v[120:123], v[140:143], v[60:63]
    v_mfma_f32_16x16x32_bf16 v[64:67], v[124:127], v[140:143], v[64:67]
    v_mfma_f32_16x16x32_bf16 v[68:71], v[128:131], v[140:143], v[68:71]
    v_mfma_f32_16x16x32_bf16 v[72:75], v[132:135], v[140:143], v[72:75]
    s_nop 7
    s_nop 7
    v_cvt_pk_bf16_f32 v56, v56, v57
    v_cvt_pk_bf16_f32 v57, v58, v59
    buffer_store_dwordx2 v[56:57], v14, s[16:19], 0 offen offset:0
    v_cvt_pk_bf16_f32 v60, v60, v61
    v_cvt_pk_bf16_f32 v61, v62, v63
    buffer_store_dwordx2 v[60:61], v14, s[16:19], 0 offen offset:32
    v_cvt_pk_bf16_f32 v64, v64, v65
    v_cvt_pk_bf16_f32 v65, v66, v67
    buffer_store_dwordx2 v[64:65], v14, s[16:19], 0 offen offset:64
    v_cvt_pk_bf16_f32 v68, v68, v69
    v_cvt_pk_bf16_f32 v69, v70, v71
    buffer_store_dwordx2 v[68:69], v14, s[16:19], 0 offen offset:96
    v_cvt_pk_bf16_f32 v72, v72, v73
    v_cvt_pk_bf16_f32 v73, v74, v75
    buffer_store_dwordx2 v[72:73], v14, s[16:19], 0 offen offset:128
    s_branch .Lk2_end
.Lk2_producer:
    s_mul_i32 s32, s26, 216
    s_add_u32 s32, s32, s30
    s_lshl_b32 s32, s32, 10
    s_mul_i32 s33, s30, 40
    s_mul_i32 s29, s27, 5
    s_add_u32 s33, s33, s29
    s_lshl_b32 s33, s33, 10
    s_add_u32 s33, s33, 8388608
    s_mul_i32 s35, s30, 5120
    s_add_u32 m0, s35, 0
    s_add_u32 s34, s33, 0
    buffer_load_dwordx4 v12, s[4:7], s34 offen lds
    s_add_u32 m0, s35, 1024
    s_add_u32 s34, s33, 1024
    buffer_load_dwordx4 v12, s[4:7], s34 offen lds
    s_add_u32 m0, s35, 2048
    s_add_u32 s34, s33, 2048
    buffer_load_dwordx4 v12, s[4:7], s34 offen lds
    s_add_u32 m0, s35, 3072
    s_add_u32 s34, s33, 3072
    buffer_load_dwordx4 v12, s[4:7], s34 offen lds
    s_add_u32 m0, s35, 4096
    s_add_u32 s34, s33, 4096
    buffer_load_dwordx4 v12, s[4:7], s34 offen lds
    s_add_u32 m0, s35, 20480
    s_add_u32 s34, s33, 163840
    buffer_load_dwordx4 v12, s[4:7], s34 offen lds
    s_add_u32 m0, s35, 21504
    s_add_u32 s34, s33, 164864
    buffer_load_dwordx4 v12, s[4:7], s34 offen lds
    s_add_u32 m0, s35, 22528
    s_add_u32 s34, s33, 165888
    buffer_load_dwordx4 v12, s[4:7], s34 offen lds
    s_add_u32 m0, s35, 23552
    s_add_u32 s34, s33, 166912
    buffer_load_dwordx4 v12, s[4:7], s34 offen lds
    s_add_u32 m0, s35, 24576
    s_add_u32 s34, s33, 167936
    buffer_load_dwordx4 v12, s[4:7], s34 offen lds
    s_add_u32 m0, s35, 40960
    s_add_u32 s34, s33, 327680
    buffer_load_dwordx4 v12, s[4:7], s34 offen lds
    s_add_u32 m0, s35, 41984
    s_add_u32 s34, s33, 328704
    buffer_load_dwordx4 v12, s[4:7], s34 offen lds
    s_add_u32 m0, s35, 43008
    s_add_u32 s34, s33, 329728
    buffer_load_dwordx4 v12, s[4:7], s34 offen lds
    s_add_u32 m0, s35, 44032
    s_add_u32 s34, s33, 330752
    buffer_load_dwordx4 v12, s[4:7], s34 offen lds
    s_add_u32 m0, s35, 45056
    s_add_u32 s34, s33, 331776
    buffer_load_dwordx4 v12, s[4:7], s34 offen lds
    s_waitcnt vmcnt(10)
    s_barrier
    s_add_u32 m0, s35, 61440
    s_add_u32 s34, s33, 491520
    buffer_load_dwordx4 v12, s[4:7], s34 offen lds
    s_add_u32 m0, s35, 62464
    s_add_u32 s34, s33, 492544
    buffer_load_dwordx4 v12, s[4:7], s34 offen lds
    s_add_u32 m0, s35, 63488
    s_add_u32 s34, s33, 493568
    buffer_load_dwordx4 v12, s[4:7], s34 offen lds
    s_add_u32 m0, s35, 64512
    s_add_u32 s34, s33, 494592
    buffer_load_dwordx4 v12, s[4:7], s34 offen lds
    s_add_u32 m0, s35, 65536
    s_add_u32 s34, s33, 495616
    buffer_load_dwordx4 v12, s[4:7], s34 offen lds
    s_add_u32 m0, s35, 81920
    s_add_u32 s34, s33, 655360
    buffer_load_dwordx4 v12, s[4:7], s34 offen lds
    s_add_u32 m0, s35, 82944
    s_add_u32 s34, s33, 656384
    buffer_load_dwordx4 v12, s[4:7], s34 offen lds
    s_add_u32 m0, s35, 83968
    s_add_u32 s34, s33, 657408
    buffer_load_dwordx4 v12, s[4:7], s34 offen lds
    s_add_u32 m0, s35, 84992
    s_add_u32 s34, s33, 658432
    buffer_load_dwordx4 v12, s[4:7], s34 offen lds
    s_add_u32 m0, s35, 86016
    s_add_u32 s34, s33, 659456
    buffer_load_dwordx4 v12, s[4:7], s34 offen lds
    s_add_u32 m0, s35, 102400
    s_add_u32 s34, s33, 819200
    buffer_load_dwordx4 v12, s[4:7], s34 offen lds
    s_add_u32 m0, s35, 103424
    s_add_u32 s34, s33, 820224
    buffer_load_dwordx4 v12, s[4:7], s34 offen lds
    s_add_u32 m0, s35, 104448
    s_add_u32 s34, s33, 821248
    buffer_load_dwordx4 v12, s[4:7], s34 offen lds
    s_add_u32 m0, s35, 105472
    s_add_u32 s34, s33, 822272
    buffer_load_dwordx4 v12, s[4:7], s34 offen lds
    s_add_u32 m0, s35, 106496
    s_add_u32 s34, s33, 823296
    buffer_load_dwordx4 v12, s[4:7], s34 offen lds
    s_add_u32 m0, s35, 122880
    s_add_u32 s34, s33, 983040
    buffer_load_dwordx4 v12, s[4:7], s34 offen lds
    s_add_u32 m0, s35, 123904
    s_add_u32 s34, s33, 984064
    buffer_load_dwordx4 v12, s[4:7], s34 offen lds
    s_add_u32 m0, s35, 124928
    s_add_u32 s34, s33, 985088
    buffer_load_dwordx4 v12, s[4:7], s34 offen lds
    s_add_u32 m0, s35, 125952
    s_add_u32 s34, s33, 986112
    buffer_load_dwordx4 v12, s[4:7], s34 offen lds
    s_add_u32 m0, s35, 126976
    s_add_u32 s34, s33, 987136
    buffer_load_dwordx4 v12, s[4:7], s34 offen lds
    s_waitcnt vmcnt(25)
    s_barrier
    s_add_u32 m0, s35, 0
    s_add_u32 s34, s33, 1146880
    buffer_load_dwordx4 v12, s[4:7], s34 offen lds
    s_add_u32 m0, s35, 1024
    s_add_u32 s34, s33, 1147904
    buffer_load_dwordx4 v12, s[4:7], s34 offen lds
    s_add_u32 m0, s35, 2048
    s_add_u32 s34, s33, 1148928
    buffer_load_dwordx4 v12, s[4:7], s34 offen lds
    s_add_u32 m0, s35, 3072
    s_add_u32 s34, s33, 1149952
    buffer_load_dwordx4 v12, s[4:7], s34 offen lds
    s_add_u32 m0, s35, 4096
    s_add_u32 s34, s33, 1150976
    buffer_load_dwordx4 v12, s[4:7], s34 offen lds
    s_waitcnt vmcnt(25)
    s_barrier
    s_add_u32 m0, s35, 20480
    s_add_u32 s34, s33, 1310720
    buffer_load_dwordx4 v12, s[4:7], s34 offen lds
    s_add_u32 m0, s35, 21504
    s_add_u32 s34, s33, 1311744
    buffer_load_dwordx4 v12, s[4:7], s34 offen lds
    s_add_u32 m0, s35, 22528
    s_add_u32 s34, s33, 1312768
    buffer_load_dwordx4 v12, s[4:7], s34 offen lds
    s_add_u32 m0, s35, 23552
    s_add_u32 s34, s33, 1313792
    buffer_load_dwordx4 v12, s[4:7], s34 offen lds
    s_add_u32 m0, s35, 24576
    s_add_u32 s34, s33, 1314816
    buffer_load_dwordx4 v12, s[4:7], s34 offen lds
    s_waitcnt vmcnt(25)
    s_barrier
    s_add_u32 m0, s35, 40960
    s_add_u32 s34, s33, 1474560
    buffer_load_dwordx4 v12, s[4:7], s34 offen lds
    s_add_u32 m0, s35, 41984
    s_add_u32 s34, s33, 1475584
    buffer_load_dwordx4 v12, s[4:7], s34 offen lds
    s_add_u32 m0, s35, 43008
    s_add_u32 s34, s33, 1476608
    buffer_load_dwordx4 v12, s[4:7], s34 offen lds
    s_add_u32 m0, s35, 44032
    s_add_u32 s34, s33, 1477632
    buffer_load_dwordx4 v12, s[4:7], s34 offen lds
    s_add_u32 m0, s35, 45056
    s_add_u32 s34, s33, 1478656
    buffer_load_dwordx4 v12, s[4:7], s34 offen lds
    s_waitcnt vmcnt(25)
    s_barrier
    s_add_u32 m0, s35, 61440
    s_add_u32 s34, s33, 1638400
    buffer_load_dwordx4 v12, s[4:7], s34 offen lds
    s_add_u32 m0, s35, 62464
    s_add_u32 s34, s33, 1639424
    buffer_load_dwordx4 v12, s[4:7], s34 offen lds
    s_add_u32 m0, s35, 63488
    s_add_u32 s34, s33, 1640448
    buffer_load_dwordx4 v12, s[4:7], s34 offen lds
    s_add_u32 m0, s35, 64512
    s_add_u32 s34, s33, 1641472
    buffer_load_dwordx4 v12, s[4:7], s34 offen lds
    s_add_u32 m0, s35, 65536
    s_add_u32 s34, s33, 1642496
    buffer_load_dwordx4 v12, s[4:7], s34 offen lds
    s_waitcnt vmcnt(25)
    s_barrier
    s_add_u32 m0, s35, 81920
    s_add_u32 s34, s33, 1802240
    buffer_load_dwordx4 v12, s[4:7], s34 offen lds
    s_add_u32 m0, s35, 82944
    s_add_u32 s34, s33, 1803264
    buffer_load_dwordx4 v12, s[4:7], s34 offen lds
    s_add_u32 m0, s35, 83968
    s_add_u32 s34, s33, 1804288
    buffer_load_dwordx4 v12, s[4:7], s34 offen lds
    s_add_u32 m0, s35, 84992
    s_add_u32 s34, s33, 1805312
    buffer_load_dwordx4 v12, s[4:7], s34 offen lds
    s_add_u32 m0, s35, 86016
    s_add_u32 s34, s33, 1806336
    buffer_load_dwordx4 v12, s[4:7], s34 offen lds
    s_waitcnt vmcnt(25)
    s_barrier
    s_add_u32 m0, s35, 102400
    s_add_u32 s34, s33, 1966080
    buffer_load_dwordx4 v12, s[4:7], s34 offen lds
    s_add_u32 m0, s35, 103424
    s_add_u32 s34, s33, 1967104
    buffer_load_dwordx4 v12, s[4:7], s34 offen lds
    s_add_u32 m0, s35, 104448
    s_add_u32 s34, s33, 1968128
    buffer_load_dwordx4 v12, s[4:7], s34 offen lds
    s_add_u32 m0, s35, 105472
    s_add_u32 s34, s33, 1969152
    buffer_load_dwordx4 v12, s[4:7], s34 offen lds
    s_add_u32 m0, s35, 106496
    s_add_u32 s34, s33, 1970176
    buffer_load_dwordx4 v12, s[4:7], s34 offen lds
    s_waitcnt vmcnt(25)
    s_barrier
    s_cmp_ge_u32 s30, 2
    s_cbranch_scc1 .Lk2_pskip13
    s_add_u32 m0, s35, 122880
    s_add_u32 s34, s33, 2129920
    buffer_load_dwordx4 v12, s[4:7], s34 offen lds
    s_add_u32 m0, s35, 123904
    s_add_u32 s34, s33, 2130944
    buffer_load_dwordx4 v12, s[4:7], s34 offen lds
    s_add_u32 m0, s35, 124928
    s_add_u32 s34, s33, 2131968
    buffer_load_dwordx4 v12, s[4:7], s34 offen lds
    s_add_u32 m0, s35, 125952
    s_add_u32 s34, s33, 2132992
    buffer_load_dwordx4 v12, s[4:7], s34 offen lds
    s_add_u32 m0, s35, 126976
    s_add_u32 s34, s33, 2134016
    buffer_load_dwordx4 v12, s[4:7], s34 offen lds
.Lk2_pskip13:
    s_waitcnt vmcnt(20)
    s_barrier
    s_waitcnt vmcnt(15)
    s_barrier
    s_waitcnt vmcnt(10)
    s_barrier
    s_waitcnt vmcnt(5)
    s_barrier
    s_waitcnt vmcnt(0)
    s_barrier
    s_waitcnt vmcnt(0)
    s_barrier
.Lk2_end:
    s_endpgm
.section .rodata,"a"
.p2align 6
.amdhsa_kernel standalone__dense_activation_squared_relu__prompt_kernel
  .amdhsa_next_free_vgpr 256
  .amdhsa_next_free_sgpr 102
  .amdhsa_accum_offset 256
  .amdhsa_group_segment_fixed_size 0
  .amdhsa_kernarg_size 64
  .amdhsa_user_sgpr_count 2
  .amdhsa_user_sgpr_kernarg_segment_ptr 1
  .amdhsa_system_sgpr_workgroup_id_x 1
.end_amdhsa_kernel
.p2align 6
.amdhsa_kernel mlp_gemm2_kernel
  .amdhsa_next_free_vgpr 256
  .amdhsa_next_free_sgpr 102
  .amdhsa_accum_offset 256
  .amdhsa_group_segment_fixed_size 0
  .amdhsa_kernarg_size 64
  .amdhsa_user_sgpr_count 2
  .amdhsa_user_sgpr_kernarg_segment_ptr 1
  .amdhsa_system_sgpr_workgroup_id_x 1
.end_amdhsa_kernel
```
